```python
import torch

def _softmax(x, axis=-1):
    return torch.softmax(x, dim=axis)
def _gelu(x):
    return torch.nn.functional.gelu(x, approximate="tanh")
def _silu(x):
    return torch.nn.functional.silu(x)
def _sigmoid(x):
    return torch.sigmoid(x)
def _layernorm(x, axis=-1, eps=1e-5):
    m = x.mean(dim=axis, keepdim=True)
    v = x.var(dim=axis, keepdim=True, unbiased=False)
    return (x - m) / torch.sqrt(v + eps)
def _scatter_add(tgt, idx, src, axis=0):
    return tgt.clone().index_add_(axis, idx, src)
def _segment_sum(src, seg, n):
    out = torch.zeros((n,) + src.shape[1:], dtype=src.dtype)
    return out.index_add_(0, seg, src)
def _pad(x, pw):
    flat = tuple(v for pair in reversed(pw) for v in pair)
    return torch.nn.functional.pad(x, flat)

kernel_name = 'standalone__mha_block_cached__near_ridge'

def setup_inputs():

    _w = (lambda a: (lambda t: t.to(torch.bfloat16) if t.is_floating_point() else t)(torch.as_tensor(a)))
    B, Sq, D = 8, 96, 512
    H, Sk, Dh = 32, 512, 128
    return {
        "x": _w((lambda *s: torch.randn(*s, dtype=torch.bfloat16) * 0.8)(B, Sq, D)),
        "k_cache": _w((lambda *s: torch.randn(*s, dtype=torch.bfloat16) * 0.8)(B, H, Sk, Dh)),
        "v_cache": _w((lambda *s: torch.randn(*s, dtype=torch.bfloat16) * 0.05)(B, H, Sk, Dh)),
        "wq": _w((lambda *s: torch.randn(*s, dtype=torch.bfloat16) * 0.8)(D, H * Dh) * (D ** -0.5)),
        "wo": _w((lambda *s: torch.randn(*s, dtype=torch.bfloat16) * 0.05)(H * Dh, D) * ((H * Dh) ** -0.5)),
    }

def reference(x, k_cache, v_cache, wq, wo):
    B, Sq, D = x.shape
    H, Dh = 32, 128
    q = (lambda x, *d: x.permute(*d))((x @ wq).reshape(B, Sq, H, Dh), 0, 2, 1, 3)
    scores = torch.einsum("bhqd,bhkd->bhqk", q, k_cache) * (Dh ** -0.5)
    p = _softmax(scores, axis=-1)
    o = torch.einsum("bhqk,bhkd->bhqd", p, v_cache)
    return (lambda x, *d: x.permute(*d))(o, 0, 2, 1, 3).reshape(B, Sq, H * Dh) @ wo
```

```asm
; @launch grid=(256,1,1) block=(256,1,1) lds=163840
.amdgcn_target "amdgcn-amd-amdhsa--gfx950"
.text
.globl standalone__mha_block_cached__near_ridge_kernel
.p2align 8
.type standalone__mha_block_cached__near_ridge_kernel,@function
standalone__mha_block_cached__near_ridge_kernel:
    s_cmp_ge_u32 s2, 256
    s_cbranch_scc1 L_end
    s_load_dwordx4 s[4:7], s[0:1], 0
    s_load_dwordx4 s[8:11], s[0:1], 16
    s_load_dwordx4 s[12:15], s[0:1], 32
    s_load_dwordx4 s[16:19], s[0:1], 48
    v_and_b32 v1, 63, v0
    s_getpc_b64 s[78:79]
L_pc:
    s_lshr_b32 s76, s2, 3
    s_lshl_b32 s76, s76, 10
    v_lshl_add_u32 v2, v1, 7, s76
    v_min_u32 v2, L_end-L_pc, v2
    s_mov_b64 exec, 0xff
    global_load_dword v250, v2, s[78:79]
    s_mov_b64 exec, -1
    v_lshrrev_b32 v2, 6, v0
    s_nop 0
    v_readfirstlane_b32 s40, v2
    s_and_b32 s41, s2, 7
    s_bfe_u32 s43, s2, 0x30003
    s_lshr_b32 s44, s2, 6
    s_lshl_b32 s45, s41, 2
    s_add_u32 s45, s45, s44
    s_lshl_b32 s46, s44, 1
    s_add_u32 s46, s46, s43
    s_cmp_lg_u32 s40, 3
    s_cbranch_scc1 L_compute
    v_lshrrev_b32 v220, 4, v1
    v_and_b32 v221, 15, v1
    v_lshrrev_b32 v223, 3, v1
    v_and_b32 v224, 7, v1
    v_xor_b32 v224, v224, v220
    v_lshlrev_b32 v224, 4, v224
    v_lshl_add_u32 v200, v223, 10, v224
    v_xor_b32 v201, 64, v200
    v_add_u32 v202, 0x3800, v200
    v_add_u32 v203, 0x5400, v201
    v_add_u32 v201, 0x1c00, v201
    v_lshlrev_b32 v222, 2, v220
    v_xor_b32 v222, v222, v221
    v_lshlrev_b32 v222, 4, v222
    v_lshl_add_u32 v204, v220, 13, v222
    v_add_u32 v205, 0x7c00, v204
    v_add_u32 v206, 0xf800, v204
    v_add_u32 v207, 0x17400, v204
    s_mul_i32 s76, s43, 98304
    s_lshl_b32 s77, s45, 8
    s_sub_u32 s78, 0x400000, s77
    s_waitcnt lgkmcnt(0)
    s_add_u32 s20, s4, s76
    s_addc_u32 s21, s5, 0
    s_mov_b32 s22, 0x18000
    s_mov_b32 s23, 0x20000
    s_add_u32 s32, s10, s77
    s_addc_u32 s33, s11, 0
    s_mov_b32 s34, s78
    s_mov_b32 s35, 0x20000
    s_mov_b32 m0, 0x4000
    s_add_u32 s76, s46, 0
    s_and_b32 s76, s76, 7
    s_lshl_b32 s79, s76, 7
    s_lshl_b32 s80, s76, 19
    buffer_load_dwordx4 v200, s[20:23], s79 offen offset:0  lds
    buffer_load_dwordx4 v201, s[20:23], s79 offen offset:1024  lds
    buffer_load_dwordx4 v202, s[20:23], s79 offen offset:2048  lds
    buffer_load_dwordx4 v203, s[20:23], s79 offen offset:3072  lds
    s_addk_i32 m0, 0x1000
    s_add_u32 s79, s79, 0x8000
    buffer_load_dwordx4 v200, s[20:23], s79 offen offset:0  lds
    buffer_load_dwordx4 v201, s[20:23], s79 offen offset:1024  lds
    buffer_load_dwordx4 v202, s[20:23], s79 offen offset:2048  lds
    buffer_load_dwordx4 v203, s[20:23], s79 offen offset:3072  lds
    s_addk_i32 m0, 0x1000
    s_add_u32 s79, s79, 0x8000
    buffer_load_dwordx4 v200, s[20:23], s79 offen offset:0  lds
    buffer_load_dwordx4 v201, s[20:23], s79 offen offset:1024  lds
    buffer_load_dwordx4 v202, s[20:23], s79 offen offset:2048  lds
    buffer_load_dwordx4 v203, s[20:23], s79 offen offset:3072  lds
    s_mov_b32 m0, 0x0
    s_nop 0
    buffer_load_dwordx4 v204, s[32:35], s80 offen offset:0  lds
    buffer_load_dwordx4 v205, s[32:35], s80 offen offset:1024  lds
    buffer_load_dwordx4 v206, s[32:35], s80 offen offset:2048  lds
    buffer_load_dwordx4 v207, s[32:35], s80 offen offset:3072  lds
    s_addk_i32 m0, 0x1000
    s_add_u32 s80, s80, 0x20000
    buffer_load_dwordx4 v204, s[32:35], s80 offen offset:0  lds
    buffer_load_dwordx4 v205, s[32:35], s80 offen offset:1024  lds
    buffer_load_dwordx4 v206, s[32:35], s80 offen offset:2048  lds
    buffer_load_dwordx4 v207, s[32:35], s80 offen offset:3072  lds
    s_addk_i32 m0, 0x1000
    s_add_u32 s80, s80, 0x20000
    buffer_load_dwordx4 v204, s[32:35], s80 offen offset:0  lds
    buffer_load_dwordx4 v205, s[32:35], s80 offen offset:1024  lds
    buffer_load_dwordx4 v206, s[32:35], s80 offen offset:2048  lds
    buffer_load_dwordx4 v207, s[32:35], s80 offen offset:3072  lds
    s_addk_i32 m0, 0x1000
    s_add_u32 s80, s80, 0x20000
    buffer_load_dwordx4 v204, s[32:35], s80 offen offset:0  lds
    buffer_load_dwordx4 v205, s[32:35], s80 offen offset:1024  lds
    buffer_load_dwordx4 v206, s[32:35], s80 offen offset:2048  lds
    buffer_load_dwordx4 v207, s[32:35], s80 offen offset:3072  lds
    s_mov_b32 m0, 0xb000
    s_add_u32 s76, s46, 1
    s_and_b32 s76, s76, 7
    s_lshl_b32 s79, s76, 7
    s_lshl_b32 s80, s76, 19
    buffer_load_dwordx4 v200, s[20:23], s79 offen offset:0  lds
    buffer_load_dwordx4 v201, s[20:23], s79 offen offset:1024  lds
    buffer_load_dwordx4 v202, s[20:23], s79 offen offset:2048  lds
    buffer_load_dwordx4 v203, s[20:23], s79 offen offset:3072  lds
    s_addk_i32 m0, 0x1000
    s_add_u32 s79, s79, 0x8000
    buffer_load_dwordx4 v200, s[20:23], s79 offen offset:0  lds
    buffer_load_dwordx4 v201, s[20:23], s79 offen offset:1024  lds
    buffer_load_dwordx4 v202, s[20:23], s79 offen offset:2048  lds
    buffer_load_dwordx4 v203, s[20:23], s79 offen offset:3072  lds
    s_addk_i32 m0, 0x1000
    s_add_u32 s79, s79, 0x8000
    buffer_load_dwordx4 v200, s[20:23], s79 offen offset:0  lds
    buffer_load_dwordx4 v201, s[20:23], s79 offen offset:1024  lds
    buffer_load_dwordx4 v202, s[20:23], s79 offen offset:2048  lds
    buffer_load_dwordx4 v203, s[20:23], s79 offen offset:3072  lds
    s_mov_b32 m0, 0x7000
    s_nop 0
    buffer_load_dwordx4 v204, s[32:35], s80 offen offset:0  lds
    buffer_load_dwordx4 v205, s[32:35], s80 offen offset:1024  lds
    buffer_load_dwordx4 v206, s[32:35], s80 offen offset:2048  lds
    buffer_load_dwordx4 v207, s[32:35], s80 offen offset:3072  lds
    s_lshl_b32 s76, s43, 5
    s_add_u32 s76, s76, s45
    s_lshl_b32 s76, s76, 17
    s_add_u32 s24, s6, s76
    s_addc_u32 s25, s7, 0
    s_mov_b32 s26, 0x20000
    s_mov_b32 s27, 0x20000
    s_add_u32 s28, s8, s76
    s_addc_u32 s29, s9, 0
    s_mov_b32 s30, 0x20000
    s_mov_b32 s31, 0x20000
    s_lshl_b32 s76, s41, 19
    s_xor_b32 s77, s44, 2
    s_lshl_b32 s77, s77, 8
    s_add_u32 s76, s76, s77
    s_sub_u32 s78, 0x80000, s77
    s_add_u32 s36, s12, s76
    s_addc_u32 s37, s13, 0
    s_mov_b32 s38, s78
    s_mov_b32 s39, 0x20000
    v_lshl_add_u32 v212, v220, 8, v222
    v_lshl_add_u32 v216, v220, 10, v222
    v_add_u32 v217, 0xc00, v216
    v_add_u32 v218, 0x1800, v216
    v_add_u32 v219, 0x2400, v216
    v_add_u32 v223, 0, v220
    v_xor_b32 v223, v223, v221
    v_lshlrev_b32 v223, 4, v223
    v_lshl_add_u32 v208, v220, 8, v223
    v_add_u32 v223, 4, v220
    v_xor_b32 v223, v223, v221
    v_lshlrev_b32 v223, 4, v223
    v_lshl_add_u32 v209, v220, 8, v223
    v_add_u32 v223, 8, v220
    v_xor_b32 v223, v223, v221
    v_lshlrev_b32 v223, 4, v223
    v_lshl_add_u32 v210, v220, 8, v223
    v_add_u32 v223, 12, v220
    v_xor_b32 v223, v223, v221
    v_lshlrev_b32 v223, 4, v223
    v_lshl_add_u32 v211, v220, 8, v223
    v_and_b32 v223, 1, v220
    v_lshlrev_b32 v223, 2, v223
    v_and_b32 v224, 7, v1
    v_xor_b32 v223, v223, v224
    v_lshlrev_b32 v223, 4, v223
    v_lshrrev_b32 v224, 3, v1
    v_lshl_add_u32 v214, v224, 8, v223
    v_add_u32 v215, 0x400, v214
    v_lshrrev_b32 v220, 5, v1
    v_mul_u32_u24 v220, 4, v220
    v_bfe_u32 v221, v1, 2, 2
    v_add_u32 v220, v220, v221
    v_lshlrev_b32 v220, 8, v220
    v_bfe_u32 v222, v1, 4, 1
    v_lshl_add_u32 v220, v222, 5, v220
    v_and_b32 v222, 1, v1
    v_lshl_add_u32 v220, v222, 4, v220
    v_bfe_u32 v222, v1, 1, 1
    v_lshl_add_u32 v220, v222, 3, v220
    v_xor_b32 v222, s40, v221
    v_lshl_add_u32 v228, v222, 6, v220
    v_mov_b32 v238, v228
    s_mov_b32 s56, s18
    s_mov_b32 s57, s19
    s_mov_b32 s58, 0x600000
    s_mov_b32 s59, 0x20000
    s_add_u32 s60, s18, 0x600000
    s_addc_u32 s61, s19, 0
    s_mov_b32 s62, 0x600000
    s_mov_b32 s63, 0x20000
    s_add_u32 s64, s18, 0xc00000
    s_addc_u32 s65, s19, 0
    s_mov_b32 s66, 0x10000
    s_mov_b32 s67, 0x20000
    s_mov_b32 s72, s16
    s_mov_b32 s73, s17
    s_mov_b32 s74, 0x100
    s_mov_b32 s75, 0x20000
    s_mul_i32 s76, s43, 98304
    s_add_u32 s68, s14, s76
    s_addc_u32 s69, s15, 0
    s_mov_b32 s70, 0x18000
    s_mov_b32 s71, 0x20000
    v_lshlrev_b32 v240, 4, v1
    v_mov_b32 v241, 0xc000
    v_add_u32 v242, 0x10000, v240
    v_add_u32 v243, 0x1c000, v240
    v_mov_b32 v248, 1
    v_min_u32 v249, 1, v1
    v_lshlrev_b32 v249, 30, v249
    s_lshl_b32 s84, s43, 12
    s_and_b32 s77, s2, 63
    s_add_u32 s76, s44, 1
    s_and_b32 s76, s76, 3
    s_lshl_b32 s76, s76, 6
    s_add_u32 s76, s76, s77
    s_mul_i32 s87, s76, 24576
    s_lshl_b32 s99, s76, 8
    s_add_u32 s76, s44, 2
    s_and_b32 s76, s76, 3
    s_lshl_b32 s76, s76, 6
    s_add_u32 s76, s76, s77
    s_mul_i32 s88, s76, 24576
    s_lshl_b32 s100, s76, 8
    s_add_u32 s76, s44, 3
    s_and_b32 s76, s76, 3
    s_lshl_b32 s76, s76, 6
    s_add_u32 s76, s76, s77
    s_mul_i32 s89, s76, 24576
    s_lshl_b32 s101, s76, 8
    v_lshrrev_b32 v234, 2, v1
    v_min_u32 v234, 2, v234
    v_add_u32 v234, 1, v234
    v_add_u32 v234, s44, v234
    v_and_b32 v234, 3, v234
    v_lshlrev_b32 v234, 6, v234
    v_add_u32 v234, s77, v234
    v_lshlrev_b32 v234, 8, v234
    v_and_b32 v235, 3, v1
    v_min_u32 v235, 2, v235
    v_lshl_add_u32 v234, v235, 2, v234
    v_mov_b64 v[236:237], 0
    v_mov_b64 v[196:197], 0
    v_mov_b64 v[198:199], 0
    s_lshl_b32 s76, s2, 8
    s_mov_b64 exec, 0xffff
    buffer_store_dwordx4 v[196:199], v240, s[64:67], s76 offen sc1
    s_mov_b64 exec, -1
    s_addk_i32 m0, 0x1000
    s_add_u32 s80, s80, 0x20000
    buffer_load_dwordx4 v204, s[32:35], s80 offen offset:0  lds
    buffer_load_dwordx4 v205, s[32:35], s80 offen offset:1024  lds
    buffer_load_dwordx4 v206, s[32:35], s80 offen offset:2048  lds
    buffer_load_dwordx4 v207, s[32:35], s80 offen offset:3072  lds
    s_addk_i32 m0, 0x1000
    s_add_u32 s80, s80, 0x20000
    buffer_load_dwordx4 v204, s[32:35], s80 offen offset:0  lds
    buffer_load_dwordx4 v205, s[32:35], s80 offen offset:1024  lds
    buffer_load_dwordx4 v206, s[32:35], s80 offen offset:2048  lds
    buffer_load_dwordx4 v207, s[32:35], s80 offen offset:3072  lds
    s_addk_i32 m0, 0x1000
    s_add_u32 s80, s80, 0x20000
    buffer_load_dwordx4 v204, s[32:35], s80 offen offset:0  lds
    buffer_load_dwordx4 v205, s[32:35], s80 offen offset:1024  lds
    buffer_load_dwordx4 v206, s[32:35], s80 offen offset:2048  lds
    buffer_load_dwordx4 v207, s[32:35], s80 offen offset:3072  lds
    s_bitcmp1_b32 s2, 6
    s_cbranch_scc1 L_nt0
    s_lshl_b32 s76, s41, 19
    s_lshr_b32 s77, s2, 3
    s_lshl_b32 s77, s77, 14
    s_add_u32 s76, s76, s77
    v_lshl_add_u32 v251, v1, 7, s76
    v_add_u32 v252, 0x2000, v251
    global_load_dword v250, v251, s[12:13]
    global_load_dword v250, v252, s[12:13]
    s_mov_b32 m0, 0x23000
    s_add_u32 s81, s84, 0x3000
    s_and_b32 s81, s81, 0x7000
    buffer_load_dwordx4 v208, s[24:27], s81 offen offset:0 nt lds
    buffer_load_dwordx4 v209, s[24:27], s81 offen offset:1024 nt lds
    buffer_load_dwordx4 v210, s[24:27], s81 offen offset:2048 nt lds
    buffer_load_dwordx4 v211, s[24:27], s81 offen offset:3072 nt lds
    s_mov_b32 m0, 0x24000
    s_add_u32 s81, s84, 0x4000
    s_and_b32 s81, s81, 0x7000
    buffer_load_dwordx4 v208, s[24:27], s81 offen offset:0 nt lds
    buffer_load_dwordx4 v209, s[24:27], s81 offen offset:1024 nt lds
    buffer_load_dwordx4 v210, s[24:27], s81 offen offset:2048 nt lds
    buffer_load_dwordx4 v211, s[24:27], s81 offen offset:3072 nt lds
    s_mov_b32 m0, 0x25000
    s_add_u32 s81, s84, 0x5000
    s_and_b32 s81, s81, 0x7000
    buffer_load_dwordx4 v208, s[24:27], s81 offen offset:0 nt lds
    buffer_load_dwordx4 v209, s[24:27], s81 offen offset:1024 nt lds
    buffer_load_dwordx4 v210, s[24:27], s81 offen offset:2048 nt lds
    buffer_load_dwordx4 v211, s[24:27], s81 offen offset:3072 nt lds
    s_mov_b32 m0, 0x26000
    s_add_u32 s81, s84, 0x6000
    s_and_b32 s81, s81, 0x7000
    buffer_load_dwordx4 v208, s[24:27], s81 offen offset:0 nt lds
    buffer_load_dwordx4 v209, s[24:27], s81 offen offset:1024 nt lds
    buffer_load_dwordx4 v210, s[24:27], s81 offen offset:2048 nt lds
    buffer_load_dwordx4 v211, s[24:27], s81 offen offset:3072 nt lds
    s_mov_b32 m0, 0x27000
    s_add_u32 s81, s84, 0x7000
    s_and_b32 s81, s81, 0x7000
    buffer_load_dwordx4 v208, s[24:27], s81 offen offset:0 nt lds
    buffer_load_dwordx4 v209, s[24:27], s81 offen offset:1024 nt lds
    buffer_load_dwordx4 v210, s[24:27], s81 offen offset:2048 nt lds
    buffer_load_dwordx4 v211, s[24:27], s81 offen offset:3072 nt lds
L_nt0:
    s_waitcnt vmcnt(28)
    s_barrier
    s_mov_b32 m0, 0x12000
    s_add_u32 s76, s46, 2
    s_and_b32 s76, s76, 7
    s_lshl_b32 s79, s76, 7
    s_lshl_b32 s80, s76, 19
    buffer_load_dwordx4 v200, s[20:23], s79 offen offset:0  lds
    buffer_load_dwordx4 v201, s[20:23], s79 offen offset:1024  lds
    buffer_load_dwordx4 v202, s[20:23], s79 offen offset:2048  lds
    buffer_load_dwordx4 v203, s[20:23], s79 offen offset:3072  lds
    s_addk_i32 m0, 0x1000
    s_add_u32 s79, s79, 0x8000
    buffer_load_dwordx4 v200, s[20:23], s79 offen offset:0  lds
    buffer_load_dwordx4 v201, s[20:23], s79 offen offset:1024  lds
    buffer_load_dwordx4 v202, s[20:23], s79 offen offset:2048  lds
    buffer_load_dwordx4 v203, s[20:23], s79 offen offset:3072  lds
    s_addk_i32 m0, 0x1000
    s_add_u32 s79, s79, 0x8000
    buffer_load_dwordx4 v200, s[20:23], s79 offen offset:0  lds
    buffer_load_dwordx4 v201, s[20:23], s79 offen offset:1024  lds
    buffer_load_dwordx4 v202, s[20:23], s79 offen offset:2048  lds
    buffer_load_dwordx4 v203, s[20:23], s79 offen offset:3072  lds
    s_mov_b32 m0, 0xe000
    s_nop 0
    buffer_load_dwordx4 v204, s[32:35], s80 offen offset:0  lds
    buffer_load_dwordx4 v205, s[32:35], s80 offen offset:1024  lds
    buffer_load_dwordx4 v206, s[32:35], s80 offen offset:2048  lds
    buffer_load_dwordx4 v207, s[32:35], s80 offen offset:3072  lds
    s_addk_i32 m0, 0x1000
    s_add_u32 s80, s80, 0x20000
    buffer_load_dwordx4 v204, s[32:35], s80 offen offset:0  lds
    buffer_load_dwordx4 v205, s[32:35], s80 offen offset:1024  lds
    buffer_load_dwordx4 v206, s[32:35], s80 offen offset:2048  lds
    buffer_load_dwordx4 v207, s[32:35], s80 offen offset:3072  lds
    s_addk_i32 m0, 0x1000
    s_add_u32 s80, s80, 0x20000
    buffer_load_dwordx4 v204, s[32:35], s80 offen offset:0  lds
    buffer_load_dwordx4 v205, s[32:35], s80 offen offset:1024  lds
    buffer_load_dwordx4 v206, s[32:35], s80 offen offset:2048  lds
    buffer_load_dwordx4 v207, s[32:35], s80 offen offset:3072  lds
    s_addk_i32 m0, 0x1000
    s_add_u32 s80, s80, 0x20000
    buffer_load_dwordx4 v204, s[32:35], s80 offen offset:0  lds
    buffer_load_dwordx4 v205, s[32:35], s80 offen offset:1024  lds
    buffer_load_dwordx4 v206, s[32:35], s80 offen offset:2048  lds
    buffer_load_dwordx4 v207, s[32:35], s80 offen offset:3072  lds
    s_mov_b32 m0, 0x19000
    s_add_u32 s76, s46, 3
    s_and_b32 s76, s76, 7
    s_lshl_b32 s79, s76, 7
    s_lshl_b32 s80, s76, 19
    buffer_load_dwordx4 v200, s[20:23], s79 offen offset:0  lds
    buffer_load_dwordx4 v201, s[20:23], s79 offen offset:1024  lds
    buffer_load_dwordx4 v202, s[20:23], s79 offen offset:2048  lds
    buffer_load_dwordx4 v203, s[20:23], s79 offen offset:3072  lds
    s_addk_i32 m0, 0x1000
    s_add_u32 s79, s79, 0x8000
    buffer_load_dwordx4 v200, s[20:23], s79 offen offset:0  lds
    buffer_load_dwordx4 v201, s[20:23], s79 offen offset:1024  lds
    buffer_load_dwordx4 v202, s[20:23], s79 offen offset:2048  lds
    buffer_load_dwordx4 v203, s[20:23], s79 offen offset:3072  lds
    s_addk_i32 m0, 0x1000
    s_add_u32 s79, s79, 0x8000
    buffer_load_dwordx4 v200, s[20:23], s79 offen offset:0  lds
    buffer_load_dwordx4 v201, s[20:23], s79 offen offset:1024  lds
    buffer_load_dwordx4 v202, s[20:23], s79 offen offset:2048  lds
    buffer_load_dwordx4 v203, s[20:23], s79 offen offset:3072  lds
    s_waitcnt vmcnt(40)
    s_barrier
    s_getreg_b32 s76, hwreg(HW_REG_XCC_ID, 0, 4)
    s_add_u32 s76, s76, 1
    s_and_b32 s77, s2, 3
    s_lshl_b32 s77, s77, 3
    s_lshl_b32 s98, s76, s77
    s_and_b32 s77, s2, 0xfc
    s_atomic_or s98, s[16:17], s77
    s_mov_b32 m0, 0x15000
    s_nop 0
    buffer_load_dwordx4 v204, s[32:35], s80 offen offset:0  lds
    buffer_load_dwordx4 v205, s[32:35], s80 offen offset:1024  lds
    buffer_load_dwordx4 v206, s[32:35], s80 offen offset:2048  lds
    buffer_load_dwordx4 v207, s[32:35], s80 offen offset:3072  lds
    s_addk_i32 m0, 0x1000
    s_add_u32 s80, s80, 0x20000
    buffer_load_dwordx4 v204, s[32:35], s80 offen offset:0  lds
    buffer_load_dwordx4 v205, s[32:35], s80 offen offset:1024  lds
    buffer_load_dwordx4 v206, s[32:35], s80 offen offset:2048  lds
    buffer_load_dwordx4 v207, s[32:35], s80 offen offset:3072  lds
    s_addk_i32 m0, 0x1000
    s_add_u32 s80, s80, 0x20000
    buffer_load_dwordx4 v204, s[32:35], s80 offen offset:0  lds
    buffer_load_dwordx4 v205, s[32:35], s80 offen offset:1024  lds
    buffer_load_dwordx4 v206, s[32:35], s80 offen offset:2048  lds
    buffer_load_dwordx4 v207, s[32:35], s80 offen offset:3072  lds
    s_addk_i32 m0, 0x1000
    s_add_u32 s80, s80, 0x20000
    buffer_load_dwordx4 v204, s[32:35], s80 offen offset:0  lds
    buffer_load_dwordx4 v205, s[32:35], s80 offen offset:1024  lds
    buffer_load_dwordx4 v206, s[32:35], s80 offen offset:2048  lds
    buffer_load_dwordx4 v207, s[32:35], s80 offen offset:3072  lds
    s_mov_b32 m0, 0x20000
    s_add_u32 s76, s46, 4
    s_and_b32 s76, s76, 7
    s_lshl_b32 s79, s76, 7
    s_lshl_b32 s80, s76, 19
    buffer_load_dwordx4 v200, s[20:23], s79 offen offset:0  lds
    buffer_load_dwordx4 v201, s[20:23], s79 offen offset:1024  lds
    buffer_load_dwordx4 v202, s[20:23], s79 offen offset:2048  lds
    buffer_load_dwordx4 v203, s[20:23], s79 offen offset:3072  lds
    s_addk_i32 m0, 0x1000
    s_add_u32 s79, s79, 0x8000
    buffer_load_dwordx4 v200, s[20:23], s79 offen offset:0  lds
    buffer_load_dwordx4 v201, s[20:23], s79 offen offset:1024  lds
    buffer_load_dwordx4 v202, s[20:23], s79 offen offset:2048  lds
    buffer_load_dwordx4 v203, s[20:23], s79 offen offset:3072  lds
    s_addk_i32 m0, 0x1000
    s_add_u32 s79, s79, 0x8000
    buffer_load_dwordx4 v200, s[20:23], s79 offen offset:0  lds
    buffer_load_dwordx4 v201, s[20:23], s79 offen offset:1024  lds
    buffer_load_dwordx4 v202, s[20:23], s79 offen offset:2048  lds
    buffer_load_dwordx4 v203, s[20:23], s79 offen offset:3072  lds
    s_mov_b32 m0, 0x1c000
    s_nop 0
    buffer_load_dwordx4 v204, s[32:35], s80 offen offset:0  lds
    buffer_load_dwordx4 v205, s[32:35], s80 offen offset:1024  lds
    buffer_load_dwordx4 v206, s[32:35], s80 offen offset:2048  lds
    buffer_load_dwordx4 v207, s[32:35], s80 offen offset:3072  lds
    s_addk_i32 m0, 0x1000
    s_add_u32 s80, s80, 0x20000
    buffer_load_dwordx4 v204, s[32:35], s80 offen offset:0  lds
    buffer_load_dwordx4 v205, s[32:35], s80 offen offset:1024  lds
    buffer_load_dwordx4 v206, s[32:35], s80 offen offset:2048  lds
    buffer_load_dwordx4 v207, s[32:35], s80 offen offset:3072  lds
    s_addk_i32 m0, 0x1000
    s_add_u32 s80, s80, 0x20000
    buffer_load_dwordx4 v204, s[32:35], s80 offen offset:0  lds
    buffer_load_dwordx4 v205, s[32:35], s80 offen offset:1024  lds
    buffer_load_dwordx4 v206, s[32:35], s80 offen offset:2048  lds
    buffer_load_dwordx4 v207, s[32:35], s80 offen offset:3072  lds
    s_addk_i32 m0, 0x1000
    s_add_u32 s80, s80, 0x20000
    buffer_load_dwordx4 v204, s[32:35], s80 offen offset:0  lds
    buffer_load_dwordx4 v205, s[32:35], s80 offen offset:1024  lds
    buffer_load_dwordx4 v206, s[32:35], s80 offen offset:2048  lds
    buffer_load_dwordx4 v207, s[32:35], s80 offen offset:3072  lds
    s_waitcnt vmcnt(56)
    s_barrier
    s_mov_b32 m0, 0x4000
    s_add_u32 s76, s46, 5
    s_and_b32 s76, s76, 7
    s_lshl_b32 s79, s76, 7
    s_lshl_b32 s80, s76, 19
    buffer_load_dwordx4 v200, s[20:23], s79 offen offset:0  lds
    buffer_load_dwordx4 v201, s[20:23], s79 offen offset:1024  lds
    buffer_load_dwordx4 v202, s[20:23], s79 offen offset:2048  lds
    buffer_load_dwordx4 v203, s[20:23], s79 offen offset:3072  lds
    s_addk_i32 m0, 0x1000
    s_add_u32 s79, s79, 0x8000
    buffer_load_dwordx4 v200, s[20:23], s79 offen offset:0  lds
    buffer_load_dwordx4 v201, s[20:23], s79 offen offset:1024  lds
    buffer_load_dwordx4 v202, s[20:23], s79 offen offset:2048  lds
    buffer_load_dwordx4 v203, s[20:23], s79 offen offset:3072  lds
    s_addk_i32 m0, 0x1000
    s_add_u32 s79, s79, 0x8000
    buffer_load_dwordx4 v200, s[20:23], s79 offen offset:0  lds
    buffer_load_dwordx4 v201, s[20:23], s79 offen offset:1024  lds
    buffer_load_dwordx4 v202, s[20:23], s79 offen offset:2048  lds
    buffer_load_dwordx4 v203, s[20:23], s79 offen offset:3072  lds
    s_mov_b32 m0, 0x0
    s_nop 0
    buffer_load_dwordx4 v204, s[32:35], s80 offen offset:0  lds
    buffer_load_dwordx4 v205, s[32:35], s80 offen offset:1024  lds
    buffer_load_dwordx4 v206, s[32:35], s80 offen offset:2048  lds
    buffer_load_dwordx4 v207, s[32:35], s80 offen offset:3072  lds
    s_addk_i32 m0, 0x1000
    s_add_u32 s80, s80, 0x20000
    buffer_load_dwordx4 v204, s[32:35], s80 offen offset:0  lds
    buffer_load_dwordx4 v205, s[32:35], s80 offen offset:1024  lds
    buffer_load_dwordx4 v206, s[32:35], s80 offen offset:2048  lds
    buffer_load_dwordx4 v207, s[32:35], s80 offen offset:3072  lds
    s_addk_i32 m0, 0x1000
    s_add_u32 s80, s80, 0x20000
    buffer_load_dwordx4 v204, s[32:35], s80 offen offset:0  lds
    buffer_load_dwordx4 v205, s[32:35], s80 offen offset:1024  lds
    buffer_load_dwordx4 v206, s[32:35], s80 offen offset:2048  lds
    buffer_load_dwordx4 v207, s[32:35], s80 offen offset:3072  lds
    s_addk_i32 m0, 0x1000
    s_add_u32 s80, s80, 0x20000
    buffer_load_dwordx4 v204, s[32:35], s80 offen offset:0  lds
    buffer_load_dwordx4 v205, s[32:35], s80 offen offset:1024  lds
    buffer_load_dwordx4 v206, s[32:35], s80 offen offset:2048  lds
    buffer_load_dwordx4 v207, s[32:35], s80 offen offset:3072  lds
    s_waitcnt vmcnt(56)
    s_barrier
    s_mov_b32 m0, 0xb000
    s_add_u32 s76, s46, 6
    s_and_b32 s76, s76, 7
    s_lshl_b32 s79, s76, 7
    s_lshl_b32 s80, s76, 19
    buffer_load_dwordx4 v200, s[20:23], s79 offen offset:0  lds
    buffer_load_dwordx4 v201, s[20:23], s79 offen offset:1024  lds
    buffer_load_dwordx4 v202, s[20:23], s79 offen offset:2048  lds
    buffer_load_dwordx4 v203, s[20:23], s79 offen offset:3072  lds
    s_addk_i32 m0, 0x1000
    s_add_u32 s79, s79, 0x8000
    buffer_load_dwordx4 v200, s[20:23], s79 offen offset:0  lds
    buffer_load_dwordx4 v201, s[20:23], s79 offen offset:1024  lds
    buffer_load_dwordx4 v202, s[20:23], s79 offen offset:2048  lds
    buffer_load_dwordx4 v203, s[20:23], s79 offen offset:3072  lds
    s_addk_i32 m0, 0x1000
    s_add_u32 s79, s79, 0x8000
    buffer_load_dwordx4 v200, s[20:23], s79 offen offset:0  lds
    buffer_load_dwordx4 v201, s[20:23], s79 offen offset:1024  lds
    buffer_load_dwordx4 v202, s[20:23], s79 offen offset:2048  lds
    buffer_load_dwordx4 v203, s[20:23], s79 offen offset:3072  lds
    s_mov_b32 m0, 0x7000
    s_nop 0
    buffer_load_dwordx4 v204, s[32:35], s80 offen offset:0  lds
    buffer_load_dwordx4 v205, s[32:35], s80 offen offset:1024  lds
    buffer_load_dwordx4 v206, s[32:35], s80 offen offset:2048  lds
    buffer_load_dwordx4 v207, s[32:35], s80 offen offset:3072  lds
    s_addk_i32 m0, 0x1000
    s_add_u32 s80, s80, 0x20000
    buffer_load_dwordx4 v204, s[32:35], s80 offen offset:0  lds
    buffer_load_dwordx4 v205, s[32:35], s80 offen offset:1024  lds
    buffer_load_dwordx4 v206, s[32:35], s80 offen offset:2048  lds
    buffer_load_dwordx4 v207, s[32:35], s80 offen offset:3072  lds
    s_addk_i32 m0, 0x1000
    s_add_u32 s80, s80, 0x20000
    buffer_load_dwordx4 v204, s[32:35], s80 offen offset:0  lds
    buffer_load_dwordx4 v205, s[32:35], s80 offen offset:1024  lds
    buffer_load_dwordx4 v206, s[32:35], s80 offen offset:2048  lds
    buffer_load_dwordx4 v207, s[32:35], s80 offen offset:3072  lds
    s_addk_i32 m0, 0x1000
    s_add_u32 s80, s80, 0x20000
    buffer_load_dwordx4 v204, s[32:35], s80 offen offset:0  lds
    buffer_load_dwordx4 v205, s[32:35], s80 offen offset:1024  lds
    buffer_load_dwordx4 v206, s[32:35], s80 offen offset:2048  lds
    buffer_load_dwordx4 v207, s[32:35], s80 offen offset:3072  lds
    s_bitcmp1_b32 s2, 6
    s_cbranch_scc0 L_nt1
    s_lshl_b32 s76, s41, 19
    s_lshr_b32 s77, s2, 3
    s_lshl_b32 s77, s77, 14
    s_add_u32 s76, s76, s77
    v_lshl_add_u32 v251, v1, 7, s76
    v_add_u32 v252, 0x2000, v251
    global_load_dword v250, v251, s[12:13]
    global_load_dword v250, v252, s[12:13]
    s_mov_b32 m0, 0x23000
    s_add_u32 s81, s84, 0x3000
    s_and_b32 s81, s81, 0x7000
    buffer_load_dwordx4 v208, s[24:27], s81 offen offset:0 nt lds
    buffer_load_dwordx4 v209, s[24:27], s81 offen offset:1024 nt lds
    buffer_load_dwordx4 v210, s[24:27], s81 offen offset:2048 nt lds
    buffer_load_dwordx4 v211, s[24:27], s81 offen offset:3072 nt lds
    s_mov_b32 m0, 0x24000
    s_add_u32 s81, s84, 0x4000
    s_and_b32 s81, s81, 0x7000
    buffer_load_dwordx4 v208, s[24:27], s81 offen offset:0 nt lds
    buffer_load_dwordx4 v209, s[24:27], s81 offen offset:1024 nt lds
    buffer_load_dwordx4 v210, s[24:27], s81 offen offset:2048 nt lds
    buffer_load_dwordx4 v211, s[24:27], s81 offen offset:3072 nt lds
    s_mov_b32 m0, 0x25000
    s_add_u32 s81, s84, 0x5000
    s_and_b32 s81, s81, 0x7000
    buffer_load_dwordx4 v208, s[24:27], s81 offen offset:0 nt lds
    buffer_load_dwordx4 v209, s[24:27], s81 offen offset:1024 nt lds
    buffer_load_dwordx4 v210, s[24:27], s81 offen offset:2048 nt lds
    buffer_load_dwordx4 v211, s[24:27], s81 offen offset:3072 nt lds
    s_mov_b32 m0, 0x26000
    s_add_u32 s81, s84, 0x6000
    s_and_b32 s81, s81, 0x7000
    buffer_load_dwordx4 v208, s[24:27], s81 offen offset:0 nt lds
    buffer_load_dwordx4 v209, s[24:27], s81 offen offset:1024 nt lds
    buffer_load_dwordx4 v210, s[24:27], s81 offen offset:2048 nt lds
    buffer_load_dwordx4 v211, s[24:27], s81 offen offset:3072 nt lds
    s_mov_b32 m0, 0x27000
    s_add_u32 s81, s84, 0x7000
    s_and_b32 s81, s81, 0x7000
    buffer_load_dwordx4 v208, s[24:27], s81 offen offset:0 nt lds
    buffer_load_dwordx4 v209, s[24:27], s81 offen offset:1024 nt lds
    buffer_load_dwordx4 v210, s[24:27], s81 offen offset:2048 nt lds
    buffer_load_dwordx4 v211, s[24:27], s81 offen offset:3072 nt lds
L_nt1:
    s_waitcnt vmcnt(56)
    s_barrier
    s_mov_b32 m0, 0x12000
    s_add_u32 s76, s46, 7
    s_and_b32 s76, s76, 7
    s_lshl_b32 s79, s76, 7
    s_lshl_b32 s80, s76, 19
    buffer_load_dwordx4 v200, s[20:23], s79 offen offset:0  lds
    buffer_load_dwordx4 v201, s[20:23], s79 offen offset:1024  lds
    buffer_load_dwordx4 v202, s[20:23], s79 offen offset:2048  lds
    buffer_load_dwordx4 v203, s[20:23], s79 offen offset:3072  lds
    s_addk_i32 m0, 0x1000
    s_add_u32 s79, s79, 0x8000
    buffer_load_dwordx4 v200, s[20:23], s79 offen offset:0  lds
    buffer_load_dwordx4 v201, s[20:23], s79 offen offset:1024  lds
    buffer_load_dwordx4 v202, s[20:23], s79 offen offset:2048  lds
    buffer_load_dwordx4 v203, s[20:23], s79 offen offset:3072  lds
    s_addk_i32 m0, 0x1000
    s_add_u32 s79, s79, 0x8000
    buffer_load_dwordx4 v200, s[20:23], s79 offen offset:0  lds
    buffer_load_dwordx4 v201, s[20:23], s79 offen offset:1024  lds
    buffer_load_dwordx4 v202, s[20:23], s79 offen offset:2048  lds
    buffer_load_dwordx4 v203, s[20:23], s79 offen offset:3072  lds
    s_mov_b32 m0, 0xe000
    s_nop 0
    buffer_load_dwordx4 v204, s[32:35], s80 offen offset:0  lds
    buffer_load_dwordx4 v205, s[32:35], s80 offen offset:1024  lds
    buffer_load_dwordx4 v206, s[32:35], s80 offen offset:2048  lds
    buffer_load_dwordx4 v207, s[32:35], s80 offen offset:3072  lds
    s_addk_i32 m0, 0x1000
    s_add_u32 s80, s80, 0x20000
    buffer_load_dwordx4 v204, s[32:35], s80 offen offset:0  lds
    buffer_load_dwordx4 v205, s[32:35], s80 offen offset:1024  lds
    buffer_load_dwordx4 v206, s[32:35], s80 offen offset:2048  lds
    buffer_load_dwordx4 v207, s[32:35], s80 offen offset:3072  lds
    s_addk_i32 m0, 0x1000
    s_add_u32 s80, s80, 0x20000
    buffer_load_dwordx4 v204, s[32:35], s80 offen offset:0  lds
    buffer_load_dwordx4 v205, s[32:35], s80 offen offset:1024  lds
    buffer_load_dwordx4 v206, s[32:35], s80 offen offset:2048  lds
    buffer_load_dwordx4 v207, s[32:35], s80 offen offset:3072  lds
    s_addk_i32 m0, 0x1000
    s_add_u32 s80, s80, 0x20000
    buffer_load_dwordx4 v204, s[32:35], s80 offen offset:0  lds
    buffer_load_dwordx4 v205, s[32:35], s80 offen offset:1024  lds
    buffer_load_dwordx4 v206, s[32:35], s80 offen offset:2048  lds
    buffer_load_dwordx4 v207, s[32:35], s80 offen offset:3072  lds
    s_waitcnt vmcnt(56)
    s_barrier
    s_waitcnt vmcnt(28)
    s_barrier
    s_waitcnt vmcnt(32)
    s_mov_b32 m0, 0x20000
    s_add_u32 s83, s84, 0x0
    s_and_b32 s81, s83, 0x7000
    buffer_load_dwordx4 v208, s[24:27], s81 offen offset:0 nt lds
    buffer_load_dwordx4 v209, s[24:27], s81 offen offset:1024 nt lds
    buffer_load_dwordx4 v210, s[24:27], s81 offen offset:2048 nt lds
    buffer_load_dwordx4 v211, s[24:27], s81 offen offset:3072 nt lds
    s_waitcnt vmcnt(32)
    s_mov_b32 m0, 0x1c000
    s_add_u32 s76, s44, 0
    s_and_b32 s76, s76, 3
    s_lshl_b32 s82, s76, 17
    buffer_load_dwordx4 v216, s[36:39], s82 offen offset:0  lds
    buffer_load_dwordx4 v217, s[36:39], s82 offen offset:1024  lds
    buffer_load_dwordx4 v218, s[36:39], s82 offen offset:2048  lds
    buffer_load_dwordx4 v219, s[36:39], s82 offen offset:3072  lds
    s_waitcnt vmcnt(32)
    s_addk_i32 m0, 0x5000
    s_addk_i32 s83, 0x1000
    s_and_b32 s81, s83, 0x7000
    buffer_load_dwordx4 v208, s[24:27], s81 offen offset:0 nt lds
    buffer_load_dwordx4 v209, s[24:27], s81 offen offset:1024 nt lds
    buffer_load_dwordx4 v210, s[24:27], s81 offen offset:2048 nt lds
    buffer_load_dwordx4 v211, s[24:27], s81 offen offset:3072 nt lds
    s_waitcnt vmcnt(32)
    s_mov_b32 m0, 0x1d000
    s_addk_i32 s82, 0x4000
    buffer_load_dwordx4 v216, s[36:39], s82 offen offset:0  lds
    buffer_load_dwordx4 v217, s[36:39], s82 offen offset:1024  lds
    buffer_load_dwordx4 v218, s[36:39], s82 offen offset:2048  lds
    buffer_load_dwordx4 v219, s[36:39], s82 offen offset:3072  lds
    s_waitcnt vmcnt(32)
    s_addk_i32 m0, 0x5000
    s_addk_i32 s83, 0x1000
    s_and_b32 s81, s83, 0x7000
    buffer_load_dwordx4 v208, s[24:27], s81 offen offset:0 nt lds
    buffer_load_dwordx4 v209, s[24:27], s81 offen offset:1024 nt lds
    buffer_load_dwordx4 v210, s[24:27], s81 offen offset:2048 nt lds
    buffer_load_dwordx4 v211, s[24:27], s81 offen offset:3072 nt lds
    s_waitcnt vmcnt(32)
    s_mov_b32 m0, 0x1e000
    s_addk_i32 s82, 0x4000
    buffer_load_dwordx4 v216, s[36:39], s82 offen offset:0  lds
    buffer_load_dwordx4 v217, s[36:39], s82 offen offset:1024  lds
    buffer_load_dwordx4 v218, s[36:39], s82 offen offset:2048  lds
    buffer_load_dwordx4 v219, s[36:39], s82 offen offset:3072  lds
    s_waitcnt vmcnt(32)
    s_addk_i32 m0, 0x1000
    s_addk_i32 s82, 0x4000
    buffer_load_dwordx4 v216, s[36:39], s82 offen offset:0  lds
    buffer_load_dwordx4 v217, s[36:39], s82 offen offset:1024  lds
    buffer_load_dwordx4 v218, s[36:39], s82 offen offset:2048  lds
    buffer_load_dwordx4 v219, s[36:39], s82 offen offset:3072  lds
    s_waitcnt vmcnt(28)
    s_barrier
    s_waitcnt vmcnt(32)
    s_mov_b32 m0, 0x0
    s_addk_i32 s82, 0x4000
    buffer_load_dwordx4 v216, s[36:39], s82 offen offset:0  lds
    buffer_load_dwordx4 v217, s[36:39], s82 offen offset:1024  lds
    buffer_load_dwordx4 v218, s[36:39], s82 offen offset:2048  lds
    buffer_load_dwordx4 v219, s[36:39], s82 offen offset:3072  lds
    s_waitcnt vmcnt(32)
    s_addk_i32 m0, 0x4000
    s_add_u32 s83, s84, 0x0
    s_and_b32 s81, s83, 0x7000
    s_or_b32 s81, s81, 0x8000
    buffer_load_dwordx4 v208, s[24:27], s81 offen offset:0 nt lds
    buffer_load_dwordx4 v209, s[24:27], s81 offen offset:1024 nt lds
    buffer_load_dwordx4 v210, s[24:27], s81 offen offset:2048 nt lds
    buffer_load_dwordx4 v211, s[24:27], s81 offen offset:3072 nt lds
    s_waitcnt vmcnt(32)
    s_addk_i32 m0, 0x1000
    s_addk_i32 s83, 0x1000
    s_and_b32 s81, s83, 0x7000
    s_or_b32 s81, s81, 0x8000
    buffer_load_dwordx4 v208, s[24:27], s81 offen offset:0 nt lds
    buffer_load_dwordx4 v209, s[24:27], s81 offen offset:1024 nt lds
    buffer_load_dwordx4 v210, s[24:27], s81 offen offset:2048 nt lds
    buffer_load_dwordx4 v211, s[24:27], s81 offen offset:3072 nt lds
    s_waitcnt vmcnt(32)
    s_mov_b32 m0, 0x1000
    s_addk_i32 s82, 0x4000
    buffer_load_dwordx4 v216, s[36:39], s82 offen offset:0  lds
    buffer_load_dwordx4 v217, s[36:39], s82 offen offset:1024  lds
    buffer_load_dwordx4 v218, s[36:39], s82 offen offset:2048  lds
    buffer_load_dwordx4 v219, s[36:39], s82 offen offset:3072  lds
    s_waitcnt vmcnt(32)
    s_addk_i32 m0, 0x5000
    s_addk_i32 s83, 0x1000
    s_and_b32 s81, s83, 0x7000
    s_or_b32 s81, s81, 0x8000
    buffer_load_dwordx4 v208, s[24:27], s81 offen offset:0 nt lds
    buffer_load_dwordx4 v209, s[24:27], s81 offen offset:1024 nt lds
    buffer_load_dwordx4 v210, s[24:27], s81 offen offset:2048 nt lds
    buffer_load_dwordx4 v211, s[24:27], s81 offen offset:3072 nt lds
    s_waitcnt vmcnt(20)
    s_barrier
    v_add_u32 v229, 0x1c000, v228
    ds_read_b64_tr_b16 a[128:129], v229 offset:0
    ds_read_b64_tr_b16 a[130:131], v229 offset:2048
    ds_read_b64_tr_b16 a[132:133], v229 offset:4096
    ds_read_b64_tr_b16 a[134:135], v229 offset:6144
    ds_read_b64_tr_b16 a[136:137], v229 offset:8192
    ds_read_b64_tr_b16 a[138:139], v229 offset:10240
    ds_read_b64_tr_b16 a[140:141], v229 offset:12288
    ds_read_b64_tr_b16 a[142:143], v229 offset:14336
    ds_write_b64 v241, v[236:237]
    ds_write_b32 v241, v236 offset:12
    s_waitcnt vmcnt(32)
    s_addk_i32 m0, 0x1000
    s_addk_i32 s83, 0x1000
    s_and_b32 s81, s83, 0x7000
    s_or_b32 s81, s81, 0x8000
    buffer_load_dwordx4 v208, s[24:27], s81 offen offset:0 nt lds
    buffer_load_dwordx4 v209, s[24:27], s81 offen offset:1024 nt lds
    buffer_load_dwordx4 v210, s[24:27], s81 offen offset:2048 nt lds
    buffer_load_dwordx4 v211, s[24:27], s81 offen offset:3072 nt lds
    s_waitcnt vmcnt(32)
    s_mov_b32 m0, 0x2000
    s_addk_i32 s82, 0x4000
    buffer_load_dwordx4 v216, s[36:39], s82 offen offset:0  lds
    buffer_load_dwordx4 v217, s[36:39], s82 offen offset:1024  lds
    buffer_load_dwordx4 v218, s[36:39], s82 offen offset:2048  lds
    buffer_load_dwordx4 v219, s[36:39], s82 offen offset:3072  lds
    s_waitcnt vmcnt(32)
    s_addk_i32 m0, 0x6000
    s_addk_i32 s83, 0x1000
    s_and_b32 s81, s83, 0x7000
    s_or_b32 s81, s81, 0x8000
    buffer_load_dwordx4 v208, s[24:27], s81 offen offset:0 nt lds
    buffer_load_dwordx4 v209, s[24:27], s81 offen offset:1024 nt lds
    buffer_load_dwordx4 v210, s[24:27], s81 offen offset:2048 nt lds
    buffer_load_dwordx4 v211, s[24:27], s81 offen offset:3072 nt lds
    s_waitcnt vmcnt(32)
    s_addk_i32 m0, 0x1000
    s_addk_i32 s83, 0x1000
    s_and_b32 s81, s83, 0x7000
    s_or_b32 s81, s81, 0x8000
    buffer_load_dwordx4 v208, s[24:27], s81 offen offset:0 nt lds
    buffer_load_dwordx4 v209, s[24:27], s81 offen offset:1024 nt lds
    buffer_load_dwordx4 v210, s[24:27], s81 offen offset:2048 nt lds
    buffer_load_dwordx4 v211, s[24:27], s81 offen offset:3072 nt lds
    s_waitcnt vmcnt(32)
    s_mov_b32 m0, 0x3000
    s_addk_i32 s82, 0x4000
    buffer_load_dwordx4 v216, s[36:39], s82 offen offset:0  lds
    buffer_load_dwordx4 v217, s[36:39], s82 offen offset:1024  lds
    buffer_load_dwordx4 v218, s[36:39], s82 offen offset:2048  lds
    buffer_load_dwordx4 v219, s[36:39], s82 offen offset:3072  lds
    s_waitcnt vmcnt(32)
    s_addk_i32 m0, 0x7000
    s_addk_i32 s83, 0x1000
    s_and_b32 s81, s83, 0x7000
    s_or_b32 s81, s81, 0x8000
    buffer_load_dwordx4 v208, s[24:27], s81 offen offset:0 nt lds
    buffer_load_dwordx4 v209, s[24:27], s81 offen offset:1024 nt lds
    buffer_load_dwordx4 v210, s[24:27], s81 offen offset:2048 nt lds
    buffer_load_dwordx4 v211, s[24:27], s81 offen offset:3072 nt lds
    s_waitcnt vmcnt(32)
    s_addk_i32 m0, 0x1000
    s_addk_i32 s83, 0x1000
    s_and_b32 s81, s83, 0x7000
    s_or_b32 s81, s81, 0x8000
    buffer_load_dwordx4 v208, s[24:27], s81 offen offset:0 nt lds
    buffer_load_dwordx4 v209, s[24:27], s81 offen offset:1024 nt lds
    buffer_load_dwordx4 v210, s[24:27], s81 offen offset:2048 nt lds
    buffer_load_dwordx4 v211, s[24:27], s81 offen offset:3072 nt lds
    s_waitcnt vmcnt(32)
    s_addk_i32 m0, 0x5000
    s_add_u32 s76, s44, 1
    s_and_b32 s76, s76, 3
    s_lshl_b32 s82, s76, 17
    buffer_load_dwordx4 v216, s[36:39], s82 offen offset:0  lds
    buffer_load_dwordx4 v217, s[36:39], s82 offen offset:1024  lds
    buffer_load_dwordx4 v218, s[36:39], s82 offen offset:2048  lds
    buffer_load_dwordx4 v219, s[36:39], s82 offen offset:3072  lds
    s_waitcnt vmcnt(32)
    s_addk_i32 m0, 0x4000
    s_add_u32 s83, s84, 0x0
    s_and_b32 s81, s83, 0x7000
    buffer_load_dwordx4 v212, s[28:31], s81 offen offset:0 nt lds
    buffer_load_dwordx4 v212, s[28:31], s81 offen offset:1024 nt lds
    buffer_load_dwordx4 v212, s[28:31], s81 offen offset:2048 nt lds
    buffer_load_dwordx4 v212, s[28:31], s81 offen offset:3072 nt lds
    s_waitcnt vmcnt(32)
    s_addk_i32 m0, 0x1000
    s_addk_i32 s83, 0x1000
    s_and_b32 s81, s83, 0x7000
    buffer_load_dwordx4 v212, s[28:31], s81 offen offset:0 nt lds
    buffer_load_dwordx4 v212, s[28:31], s81 offen offset:1024 nt lds
    buffer_load_dwordx4 v212, s[28:31], s81 offen offset:2048 nt lds
    buffer_load_dwordx4 v212, s[28:31], s81 offen offset:3072 nt lds
    s_waitcnt vmcnt(32)
    s_mov_b32 m0, 0x11000
    s_addk_i32 s82, 0x4000
    buffer_load_dwordx4 v216, s[36:39], s82 offen offset:0  lds
    buffer_load_dwordx4 v217, s[36:39], s82 offen offset:1024  lds
    buffer_load_dwordx4 v218, s[36:39], s82 offen offset:2048  lds
    buffer_load_dwordx4 v219, s[36:39], s82 offen offset:3072  lds
    s_waitcnt vmcnt(32)
    s_addk_i32 m0, 0x5000
    s_addk_i32 s83, 0x1000
    s_and_b32 s81, s83, 0x7000
    buffer_load_dwordx4 v212, s[28:31], s81 offen offset:0 nt lds
    buffer_load_dwordx4 v212, s[28:31], s81 offen offset:1024 nt lds
    buffer_load_dwordx4 v212, s[28:31], s81 offen offset:2048 nt lds
    buffer_load_dwordx4 v212, s[28:31], s81 offen offset:3072 nt lds
    s_waitcnt vmcnt(32)
    s_addk_i32 m0, 0x1000
    s_addk_i32 s83, 0x1000
    s_and_b32 s81, s83, 0x7000
    buffer_load_dwordx4 v212, s[28:31], s81 offen offset:0 nt lds
    buffer_load_dwordx4 v212, s[28:31], s81 offen offset:1024 nt lds
    buffer_load_dwordx4 v212, s[28:31], s81 offen offset:2048 nt lds
    buffer_load_dwordx4 v212, s[28:31], s81 offen offset:3072 nt lds
    s_waitcnt vmcnt(32)
    s_mov_b32 m0, 0x12000
    s_addk_i32 s82, 0x4000
    buffer_load_dwordx4 v216, s[36:39], s82 offen offset:0  lds
    buffer_load_dwordx4 v217, s[36:39], s82 offen offset:1024  lds
    buffer_load_dwordx4 v218, s[36:39], s82 offen offset:2048  lds
    buffer_load_dwordx4 v219, s[36:39], s82 offen offset:3072  lds
    s_waitcnt vmcnt(32)
    s_addk_i32 m0, 0x6000
    s_addk_i32 s83, 0x1000
    s_and_b32 s81, s83, 0x7000
    buffer_load_dwordx4 v212, s[28:31], s81 offen offset:0 nt lds
    buffer_load_dwordx4 v212, s[28:31], s81 offen offset:1024 nt lds
    buffer_load_dwordx4 v212, s[28:31], s81 offen offset:2048 nt lds
    buffer_load_dwordx4 v212, s[28:31], s81 offen offset:3072 nt lds
    s_waitcnt vmcnt(32) lgkmcnt(0)
    s_barrier
    v_add_u32 v229, 0x0, v228
    ds_read_b64_tr_b16 a[144:145], v229 offset:0
    ds_read_b64_tr_b16 a[146:147], v229 offset:2048
    ds_read_b64_tr_b16 a[148:149], v229 offset:4096
    ds_read_b64_tr_b16 a[150:151], v229 offset:6144
    ds_read_b64_tr_b16 a[152:153], v229 offset:8192
    ds_read_b64_tr_b16 a[154:155], v229 offset:10240
    ds_read_b64_tr_b16 a[156:157], v229 offset:12288
    ds_read_b64_tr_b16 a[158:159], v229 offset:14336
    s_waitcnt vmcnt(32)
    s_addk_i32 m0, 0x1000
    s_addk_i32 s83, 0x1000
    s_and_b32 s81, s83, 0x7000
    buffer_load_dwordx4 v212, s[28:31], s81 offen offset:0 nt lds
    buffer_load_dwordx4 v212, s[28:31], s81 offen offset:1024 nt lds
    buffer_load_dwordx4 v212, s[28:31], s81 offen offset:2048 nt lds
    buffer_load_dwordx4 v212, s[28:31], s81 offen offset:3072 nt lds
    s_waitcnt vmcnt(32)
    s_mov_b32 m0, 0x13000
    s_addk_i32 s82, 0x4000
    buffer_load_dwordx4 v216, s[36:39], s82 offen offset:0  lds
    buffer_load_dwordx4 v217, s[36:39], s82 offen offset:1024  lds
    buffer_load_dwordx4 v218, s[36:39], s82 offen offset:2048  lds
    buffer_load_dwordx4 v219, s[36:39], s82 offen offset:3072  lds
    s_waitcnt vmcnt(32)
    s_addk_i32 m0, 0x7000
    s_addk_i32 s83, 0x1000
    s_and_b32 s81, s83, 0x7000
    buffer_load_dwordx4 v212, s[28:31], s81 offen offset:0 nt lds
    buffer_load_dwordx4 v212, s[28:31], s81 offen offset:1024 nt lds
    buffer_load_dwordx4 v212, s[28:31], s81 offen offset:2048 nt lds
    buffer_load_dwordx4 v212, s[28:31], s81 offen offset:3072 nt lds
    s_waitcnt vmcnt(32)
    s_addk_i32 m0, 0x1000
    s_addk_i32 s83, 0x1000
    s_and_b32 s81, s83, 0x7000
    buffer_load_dwordx4 v212, s[28:31], s81 offen offset:0 nt lds
    buffer_load_dwordx4 v212, s[28:31], s81 offen offset:1024 nt lds
    buffer_load_dwordx4 v212, s[28:31], s81 offen offset:2048 nt lds
    buffer_load_dwordx4 v212, s[28:31], s81 offen offset:3072 nt lds
    s_waitcnt vmcnt(32)
    s_addk_i32 m0, 0x1000
    s_addk_i32 s82, 0x4000
    buffer_load_dwordx4 v216, s[36:39], s82 offen offset:0  lds
    buffer_load_dwordx4 v217, s[36:39], s82 offen offset:1024  lds
    buffer_load_dwordx4 v218, s[36:39], s82 offen offset:2048  lds
    buffer_load_dwordx4 v219, s[36:39], s82 offen offset:3072  lds
    s_waitcnt vmcnt(32)
    s_addk_i32 m0, 0x4000
    s_add_u32 s83, s84, 0x0
    s_and_b32 s81, s83, 0x7000
    s_or_b32 s81, s81, 0x10000
    buffer_load_dwordx4 v208, s[24:27], s81 offen offset:0 nt lds
    buffer_load_dwordx4 v209, s[24:27], s81 offen offset:1024 nt lds
    buffer_load_dwordx4 v210, s[24:27], s81 offen offset:2048 nt lds
    buffer_load_dwordx4 v211, s[24:27], s81 offen offset:3072 nt lds
    s_waitcnt vmcnt(32)
    s_addk_i32 m0, 0x1000
    s_addk_i32 s83, 0x1000
    s_and_b32 s81, s83, 0x7000
    s_or_b32 s81, s81, 0x10000
    buffer_load_dwordx4 v208, s[24:27], s81 offen offset:0 nt lds
    buffer_load_dwordx4 v209, s[24:27], s81 offen offset:1024 nt lds
    buffer_load_dwordx4 v210, s[24:27], s81 offen offset:2048 nt lds
    buffer_load_dwordx4 v211, s[24:27], s81 offen offset:3072 nt lds
    s_waitcnt vmcnt(32)
    s_mov_b32 m0, 0x1d000
    s_addk_i32 s82, 0x4000
    buffer_load_dwordx4 v216, s[36:39], s82 offen offset:0  lds
    buffer_load_dwordx4 v217, s[36:39], s82 offen offset:1024  lds
    buffer_load_dwordx4 v218, s[36:39], s82 offen offset:2048  lds
    buffer_load_dwordx4 v219, s[36:39], s82 offen offset:3072  lds
    s_waitcnt vmcnt(32)
    s_addk_i32 m0, 0x5000
    s_addk_i32 s83, 0x1000
    s_and_b32 s81, s83, 0x7000
    s_or_b32 s81, s81, 0x10000
    buffer_load_dwordx4 v208, s[24:27], s81 offen offset:0 nt lds
    buffer_load_dwordx4 v209, s[24:27], s81 offen offset:1024 nt lds
    buffer_load_dwordx4 v210, s[24:27], s81 offen offset:2048 nt lds
    buffer_load_dwordx4 v211, s[24:27], s81 offen offset:3072 nt lds
    s_waitcnt vmcnt(32)
    s_addk_i32 m0, 0x1000
    s_addk_i32 s83, 0x1000
    s_and_b32 s81, s83, 0x7000
    s_or_b32 s81, s81, 0x10000
    buffer_load_dwordx4 v208, s[24:27], s81 offen offset:0 nt lds
    buffer_load_dwordx4 v209, s[24:27], s81 offen offset:1024 nt lds
    buffer_load_dwordx4 v210, s[24:27], s81 offen offset:2048 nt lds
    buffer_load_dwordx4 v211, s[24:27], s81 offen offset:3072 nt lds
    s_waitcnt vmcnt(32)
    s_mov_b32 m0, 0x1e000
    s_addk_i32 s82, 0x4000
    buffer_load_dwordx4 v216, s[36:39], s82 offen offset:0  lds
    buffer_load_dwordx4 v217, s[36:39], s82 offen offset:1024  lds
    buffer_load_dwordx4 v218, s[36:39], s82 offen offset:2048  lds
    buffer_load_dwordx4 v219, s[36:39], s82 offen offset:3072  lds
    s_waitcnt vmcnt(32)
    s_addk_i32 m0, 0x6000
    s_addk_i32 s83, 0x1000
    s_and_b32 s81, s83, 0x7000
    s_or_b32 s81, s81, 0x10000
    buffer_load_dwordx4 v208, s[24:27], s81 offen offset:0 nt lds
    buffer_load_dwordx4 v209, s[24:27], s81 offen offset:1024 nt lds
    buffer_load_dwordx4 v210, s[24:27], s81 offen offset:2048 nt lds
    buffer_load_dwordx4 v211, s[24:27], s81 offen offset:3072 nt lds
    s_waitcnt vmcnt(32) lgkmcnt(0)
    s_barrier
    v_add_u32 v229, 0x10000, v228
    ds_read_b64_tr_b16 a[160:161], v229 offset:0
    ds_read_b64_tr_b16 a[162:163], v229 offset:2048
    ds_read_b64_tr_b16 a[164:165], v229 offset:4096
    ds_read_b64_tr_b16 a[166:167], v229 offset:6144
    ds_read_b64_tr_b16 a[168:169], v229 offset:8192
    ds_read_b64_tr_b16 a[170:171], v229 offset:10240
    ds_read_b64_tr_b16 a[172:173], v229 offset:12288
    ds_read_b64_tr_b16 a[174:175], v229 offset:14336
    s_waitcnt vmcnt(32)
    s_addk_i32 m0, 0x1000
    s_addk_i32 s83, 0x1000
    s_and_b32 s81, s83, 0x7000
    s_or_b32 s81, s81, 0x10000
    buffer_load_dwordx4 v208, s[24:27], s81 offen offset:0 nt lds
    buffer_load_dwordx4 v209, s[24:27], s81 offen offset:1024 nt lds
    buffer_load_dwordx4 v210, s[24:27], s81 offen offset:2048 nt lds
    buffer_load_dwordx4 v211, s[24:27], s81 offen offset:3072 nt lds
    s_waitcnt vmcnt(32)
    s_mov_b32 m0, 0x1f000
    s_addk_i32 s82, 0x4000
    buffer_load_dwordx4 v216, s[36:39], s82 offen offset:0  lds
    buffer_load_dwordx4 v217, s[36:39], s82 offen offset:1024  lds
    buffer_load_dwordx4 v218, s[36:39], s82 offen offset:2048  lds
    buffer_load_dwordx4 v219, s[36:39], s82 offen offset:3072  lds
    s_waitcnt vmcnt(32)
    s_addk_i32 m0, 0x7000
    s_addk_i32 s83, 0x1000
    s_and_b32 s81, s83, 0x7000
    s_or_b32 s81, s81, 0x10000
    buffer_load_dwordx4 v208, s[24:27], s81 offen offset:0 nt lds
    buffer_load_dwordx4 v209, s[24:27], s81 offen offset:1024 nt lds
    buffer_load_dwordx4 v210, s[24:27], s81 offen offset:2048 nt lds
    buffer_load_dwordx4 v211, s[24:27], s81 offen offset:3072 nt lds
    s_waitcnt vmcnt(32)
    s_addk_i32 m0, 0x1000
    s_addk_i32 s83, 0x1000
    s_and_b32 s81, s83, 0x7000
    s_or_b32 s81, s81, 0x10000
    buffer_load_dwordx4 v208, s[24:27], s81 offen offset:0 nt lds
    buffer_load_dwordx4 v209, s[24:27], s81 offen offset:1024 nt lds
    buffer_load_dwordx4 v210, s[24:27], s81 offen offset:2048 nt lds
    buffer_load_dwordx4 v211, s[24:27], s81 offen offset:3072 nt lds
    s_waitcnt vmcnt(32)
    s_mov_b32 m0, 0x0
    s_add_u32 s76, s44, 2
    s_and_b32 s76, s76, 3
    s_lshl_b32 s82, s76, 17
    buffer_load_dwordx4 v216, s[36:39], s82 offen offset:0  lds
    buffer_load_dwordx4 v217, s[36:39], s82 offen offset:1024  lds
    buffer_load_dwordx4 v218, s[36:39], s82 offen offset:2048  lds
    buffer_load_dwordx4 v219, s[36:39], s82 offen offset:3072  lds
    s_waitcnt vmcnt(32)
    s_addk_i32 m0, 0x4000
    s_add_u32 s83, s84, 0x0
    s_and_b32 s81, s83, 0x7000
    s_or_b32 s81, s81, 0x8000
    buffer_load_dwordx4 v212, s[28:31], s81 offen offset:0 nt lds
    buffer_load_dwordx4 v212, s[28:31], s81 offen offset:1024 nt lds
    buffer_load_dwordx4 v212, s[28:31], s81 offen offset:2048 nt lds
    buffer_load_dwordx4 v212, s[28:31], s81 offen offset:3072 nt lds
    s_waitcnt vmcnt(32)
    s_addk_i32 m0, 0x1000
    s_addk_i32 s83, 0x1000
    s_and_b32 s81, s83, 0x7000
    s_or_b32 s81, s81, 0x8000
    buffer_load_dwordx4 v212, s[28:31], s81 offen offset:0 nt lds
    buffer_load_dwordx4 v212, s[28:31], s81 offen offset:1024 nt lds
    buffer_load_dwordx4 v212, s[28:31], s81 offen offset:2048 nt lds
    buffer_load_dwordx4 v212, s[28:31], s81 offen offset:3072 nt lds
    s_waitcnt vmcnt(32)
    s_mov_b32 m0, 0x1000
    s_addk_i32 s82, 0x4000
    buffer_load_dwordx4 v216, s[36:39], s82 offen offset:0  lds
    buffer_load_dwordx4 v217, s[36:39], s82 offen offset:1024  lds
    buffer_load_dwordx4 v218, s[36:39], s82 offen offset:2048  lds
    buffer_load_dwordx4 v219, s[36:39], s82 offen offset:3072  lds
    s_waitcnt vmcnt(32)
    s_addk_i32 m0, 0x5000
    s_addk_i32 s83, 0x1000
    s_and_b32 s81, s83, 0x7000
    s_or_b32 s81, s81, 0x8000
    buffer_load_dwordx4 v212, s[28:31], s81 offen offset:0 nt lds
    buffer_load_dwordx4 v212, s[28:31], s81 offen offset:1024 nt lds
    buffer_load_dwordx4 v212, s[28:31], s81 offen offset:2048 nt lds
    buffer_load_dwordx4 v212, s[28:31], s81 offen offset:3072 nt lds
    s_waitcnt vmcnt(32)
    s_addk_i32 m0, 0x1000
    s_addk_i32 s83, 0x1000
    s_and_b32 s81, s83, 0x7000
    s_or_b32 s81, s81, 0x8000
    buffer_load_dwordx4 v212, s[28:31], s81 offen offset:0 nt lds
    buffer_load_dwordx4 v212, s[28:31], s81 offen offset:1024 nt lds
    buffer_load_dwordx4 v212, s[28:31], s81 offen offset:2048 nt lds
    buffer_load_dwordx4 v212, s[28:31], s81 offen offset:3072 nt lds
    s_waitcnt vmcnt(32)
    s_mov_b32 m0, 0x2000
    s_addk_i32 s82, 0x4000
    buffer_load_dwordx4 v216, s[36:39], s82 offen offset:0  lds
    buffer_load_dwordx4 v217, s[36:39], s82 offen offset:1024  lds
    buffer_load_dwordx4 v218, s[36:39], s82 offen offset:2048  lds
    buffer_load_dwordx4 v219, s[36:39], s82 offen offset:3072  lds
    s_waitcnt vmcnt(32)
    s_addk_i32 m0, 0x6000
    s_addk_i32 s83, 0x1000
    s_and_b32 s81, s83, 0x7000
    s_or_b32 s81, s81, 0x8000
    buffer_load_dwordx4 v212, s[28:31], s81 offen offset:0 nt lds
    buffer_load_dwordx4 v212, s[28:31], s81 offen offset:1024 nt lds
    buffer_load_dwordx4 v212, s[28:31], s81 offen offset:2048 nt lds
    buffer_load_dwordx4 v212, s[28:31], s81 offen offset:3072 nt lds
    s_waitcnt vmcnt(32) lgkmcnt(0)
    s_barrier
    v_add_u32 v229, 0x1c000, v228
    ds_read_b64_tr_b16 a[176:177], v229 offset:0
    ds_read_b64_tr_b16 a[178:179], v229 offset:2048
    ds_read_b64_tr_b16 a[180:181], v229 offset:4096
    ds_read_b64_tr_b16 a[182:183], v229 offset:6144
    ds_read_b64_tr_b16 a[184:185], v229 offset:8192
    ds_read_b64_tr_b16 a[186:187], v229 offset:10240
    ds_read_b64_tr_b16 a[188:189], v229 offset:12288
    ds_read_b64_tr_b16 a[190:191], v229 offset:14336
    s_and_b32 s76, s2, 0xf8
    s_load_dwordx2 s[8:9], s[16:17], s76
    s_and_b32 s76, s2, 0x3c
    s_load_dword s4, s[16:17], s76
    s_add_u32 s76, s76, 64
    s_load_dword s5, s[16:17], s76
    s_add_u32 s76, s76, 64
    s_load_dword s6, s[16:17], s76
    s_add_u32 s76, s76, 64
    s_load_dword s7, s[16:17], s76
    s_waitcnt vmcnt(32)
    s_addk_i32 m0, 0x1000
    s_addk_i32 s83, 0x1000
    s_and_b32 s81, s83, 0x7000
    s_or_b32 s81, s81, 0x8000
    buffer_load_dwordx4 v212, s[28:31], s81 offen offset:0 nt lds
    buffer_load_dwordx4 v212, s[28:31], s81 offen offset:1024 nt lds
    buffer_load_dwordx4 v212, s[28:31], s81 offen offset:2048 nt lds
    buffer_load_dwordx4 v212, s[28:31], s81 offen offset:3072 nt lds
    s_waitcnt vmcnt(32)
    s_mov_b32 m0, 0x3000
    s_addk_i32 s82, 0x4000
    buffer_load_dwordx4 v216, s[36:39], s82 offen offset:0  lds
    buffer_load_dwordx4 v217, s[36:39], s82 offen offset:1024  lds
    buffer_load_dwordx4 v218, s[36:39], s82 offen offset:2048  lds
    buffer_load_dwordx4 v219, s[36:39], s82 offen offset:3072  lds
    s_waitcnt vmcnt(32)
    s_addk_i32 m0, 0x7000
    s_addk_i32 s83, 0x1000
    s_and_b32 s81, s83, 0x7000
    s_or_b32 s81, s81, 0x8000
    buffer_load_dwordx4 v212, s[28:31], s81 offen offset:0 nt lds
    buffer_load_dwordx4 v212, s[28:31], s81 offen offset:1024 nt lds
    buffer_load_dwordx4 v212, s[28:31], s81 offen offset:2048 nt lds
    buffer_load_dwordx4 v212, s[28:31], s81 offen offset:3072 nt lds
    s_waitcnt vmcnt(32)
    s_addk_i32 m0, 0x1000
    s_addk_i32 s83, 0x1000
    s_and_b32 s81, s83, 0x7000
    s_or_b32 s81, s81, 0x8000
    buffer_load_dwordx4 v212, s[28:31], s81 offen offset:0 nt lds
    buffer_load_dwordx4 v212, s[28:31], s81 offen offset:1024 nt lds
    buffer_load_dwordx4 v212, s[28:31], s81 offen offset:2048 nt lds
    buffer_load_dwordx4 v212, s[28:31], s81 offen offset:3072 nt lds
    s_waitcnt vmcnt(32)
    s_addk_i32 m0, 0x5000
    s_addk_i32 s82, 0x4000
    buffer_load_dwordx4 v216, s[36:39], s82 offen offset:0  lds
    buffer_load_dwordx4 v217, s[36:39], s82 offen offset:1024  lds
    buffer_load_dwordx4 v218, s[36:39], s82 offen offset:2048  lds
    buffer_load_dwordx4 v219, s[36:39], s82 offen offset:3072  lds
    s_waitcnt vmcnt(32)
    s_addk_i32 m0, 0x4000
    s_add_u32 s83, s84, 0x0
    s_and_b32 s81, s83, 0x7000
    s_or_b32 s81, s81, 0x18000
    buffer_load_dwordx4 v208, s[24:27], s81 offen offset:0 nt lds
    buffer_load_dwordx4 v209, s[24:27], s81 offen offset:1024 nt lds
    buffer_load_dwordx4 v210, s[24:27], s81 offen offset:2048 nt lds
    buffer_load_dwordx4 v211, s[24:27], s81 offen offset:3072 nt lds
    s_waitcnt vmcnt(32)
    s_addk_i32 m0, 0x1000
    s_addk_i32 s83, 0x1000
    s_and_b32 s81, s83, 0x7000
    s_or_b32 s81, s81, 0x18000
    buffer_load_dwordx4 v208, s[24:27], s81 offen offset:0 nt lds
    buffer_load_dwordx4 v209, s[24:27], s81 offen offset:1024 nt lds
    buffer_load_dwordx4 v210, s[24:27], s81 offen offset:2048 nt lds
    buffer_load_dwordx4 v211, s[24:27], s81 offen offset:3072 nt lds
    s_waitcnt vmcnt(32)
    s_mov_b32 m0, 0x11000
    s_addk_i32 s82, 0x4000
    buffer_load_dwordx4 v216, s[36:39], s82 offen offset:0  lds
    buffer_load_dwordx4 v217, s[36:39], s82 offen offset:1024  lds
    buffer_load_dwordx4 v218, s[36:39], s82 offen offset:2048  lds
    buffer_load_dwordx4 v219, s[36:39], s82 offen offset:3072  lds
    s_waitcnt vmcnt(32)
    s_addk_i32 m0, 0x5000
    s_addk_i32 s83, 0x1000
    s_and_b32 s81, s83, 0x7000
    s_or_b32 s81, s81, 0x18000
    buffer_load_dwordx4 v208, s[24:27], s81 offen offset:0 nt lds
    buffer_load_dwordx4 v209, s[24:27], s81 offen offset:1024 nt lds
    buffer_load_dwordx4 v210, s[24:27], s81 offen offset:2048 nt lds
    buffer_load_dwordx4 v211, s[24:27], s81 offen offset:3072 nt lds
    s_waitcnt vmcnt(32)
    s_addk_i32 m0, 0x1000
    s_addk_i32 s83, 0x1000
    s_and_b32 s81, s83, 0x7000
    s_or_b32 s81, s81, 0x18000
    buffer_load_dwordx4 v208, s[24:27], s81 offen offset:0 nt lds
    buffer_load_dwordx4 v209, s[24:27], s81 offen offset:1024 nt lds
    buffer_load_dwordx4 v210, s[24:27], s81 offen offset:2048 nt lds
    buffer_load_dwordx4 v211, s[24:27], s81 offen offset:3072 nt lds
    s_waitcnt vmcnt(32)
    s_mov_b32 m0, 0x12000
    s_addk_i32 s82, 0x4000
    buffer_load_dwordx4 v216, s[36:39], s82 offen offset:0  lds
    buffer_load_dwordx4 v217, s[36:39], s82 offen offset:1024  lds
    buffer_load_dwordx4 v218, s[36:39], s82 offen offset:2048  lds
    buffer_load_dwordx4 v219, s[36:39], s82 offen offset:3072  lds
    s_waitcnt vmcnt(32)
    s_addk_i32 m0, 0x6000
    s_addk_i32 s83, 0x1000
    s_and_b32 s81, s83, 0x7000
    s_or_b32 s81, s81, 0x18000
    buffer_load_dwordx4 v208, s[24:27], s81 offen offset:0 nt lds
    buffer_load_dwordx4 v209, s[24:27], s81 offen offset:1024 nt lds
    buffer_load_dwordx4 v210, s[24:27], s81 offen offset:2048 nt lds
    buffer_load_dwordx4 v211, s[24:27], s81 offen offset:3072 nt lds
    s_waitcnt vmcnt(32) lgkmcnt(0)
    s_barrier
    v_add_u32 v229, 0x0, v228
    ds_read_b64_tr_b16 a[192:193], v229 offset:0
    ds_read_b64_tr_b16 a[194:195], v229 offset:2048
    ds_read_b64_tr_b16 a[196:197], v229 offset:4096
    ds_read_b64_tr_b16 a[198:199], v229 offset:6144
    ds_read_b64_tr_b16 a[200:201], v229 offset:8192
    ds_read_b64_tr_b16 a[202:203], v229 offset:10240
    ds_read_b64_tr_b16 a[204:205], v229 offset:12288
    ds_read_b64_tr_b16 a[206:207], v229 offset:14336
    s_mov_b32 s78, 0
L_chk:
    s_and_b32 s76, s2, 3
    s_lshl_b32 s76, s76, 3
    s_or_b32 s76, s76, 0x80000
    s_bfe_u32 s4, s4, s76
    s_bfe_u32 s5, s5, s76
    s_bfe_u32 s6, s6, s76
    s_bfe_u32 s7, s7, s76
    s_min_u32 s76, s4, s5
    s_min_u32 s77, s6, s7
    s_min_u32 s76, s76, s77
    s_add_u32 s8, s8, 0x7f7f7f7f
    s_add_u32 s9, s9, 0x7f7f7f7f
    s_and_b32 s8, s8, s9
    s_or_b32 s8, s8, 0x7f7f7f7f
    s_cmp_eq_u32 s8, -1
    s_cselect_b32 s76, s76, 0
    s_cmp_lg_u32 s76, 0
    s_cbranch_scc1 L_chk_ok
    v_lshlrev_b32 v196, 2, v1
    buffer_load_dword v197, v196, s[72:75], 0 offen sc1
    s_bfe_u32 s76, s2, 0x40002
    s_waitcnt vmcnt(0)
    v_readlane_b32 s4, v197, s76
    s_add_u32 s76, s76, 16
    v_readlane_b32 s5, v197, s76
    s_add_u32 s76, s76, 16
    v_readlane_b32 s6, v197, s76
    s_add_u32 s76, s76, 16
    v_readlane_b32 s7, v197, s76
    s_add_u32 s76, s76, 16
    s_lshr_b32 s76, s2, 3
    s_lshl_b32 s76, s76, 1
    v_readlane_b32 s8, v197, s76
    s_add_u32 s76, s76, 1
    v_readlane_b32 s9, v197, s76
    s_add_u32 s78, s78, 1
    s_cmp_lt_u32 s78, 0x400000
    s_cbranch_scc1 L_chk
L_chk_ok:
    s_xor_b32 s5, s5, s4
    s_xor_b32 s6, s6, s4
    s_xor_b32 s7, s7, s4
    s_or_b32 s76, s5, s6
    s_or_b32 s55, s76, s7
    v_mov_b32 v196, s55
    ds_write_b32 v241, v196 offset:8
    s_waitcnt vmcnt(32)
    s_addk_i32 m0, 0x1000
    s_addk_i32 s83, 0x1000
    s_and_b32 s81, s83, 0x7000
    s_or_b32 s81, s81, 0x18000
    buffer_load_dwordx4 v208, s[24:27], s81 offen offset:0 nt lds
    buffer_load_dwordx4 v209, s[24:27], s81 offen offset:1024 nt lds
    buffer_load_dwordx4 v210, s[24:27], s81 offen offset:2048 nt lds
    buffer_load_dwordx4 v211, s[24:27], s81 offen offset:3072 nt lds
    s_waitcnt vmcnt(32)
    s_mov_b32 m0, 0x13000
    s_addk_i32 s82, 0x4000
    buffer_load_dwordx4 v216, s[36:39], s82 offen offset:0  lds
    buffer_load_dwordx4 v217, s[36:39], s82 offen offset:1024  lds
    buffer_load_dwordx4 v218, s[36:39], s82 offen offset:2048  lds
    buffer_load_dwordx4 v219, s[36:39], s82 offen offset:3072  lds
    s_waitcnt vmcnt(32)
    s_addk_i32 m0, 0x7000
    s_addk_i32 s83, 0x1000
    s_and_b32 s81, s83, 0x7000
    s_or_b32 s81, s81, 0x18000
    buffer_load_dwordx4 v208, s[24:27], s81 offen offset:0 nt lds
    buffer_load_dwordx4 v209, s[24:27], s81 offen offset:1024 nt lds
    buffer_load_dwordx4 v210, s[24:27], s81 offen offset:2048 nt lds
    buffer_load_dwordx4 v211, s[24:27], s81 offen offset:3072 nt lds
    s_waitcnt vmcnt(32)
    s_addk_i32 m0, 0x1000
    s_addk_i32 s83, 0x1000
    s_and_b32 s81, s83, 0x7000
    s_or_b32 s81, s81, 0x18000
    buffer_load_dwordx4 v208, s[24:27], s81 offen offset:0 nt lds
    buffer_load_dwordx4 v209, s[24:27], s81 offen offset:1024 nt lds
    buffer_load_dwordx4 v210, s[24:27], s81 offen offset:2048 nt lds
    buffer_load_dwordx4 v211, s[24:27], s81 offen offset:3072 nt lds
    s_addk_i32 m0, 0x1000
    s_add_u32 s76, s44, 3
    s_and_b32 s76, s76, 3
    s_lshl_b32 s82, s76, 17
    buffer_load_dwordx4 v216, s[36:39], s82 offen offset:0  lds
    buffer_load_dwordx4 v217, s[36:39], s82 offen offset:1024  lds
    buffer_load_dwordx4 v218, s[36:39], s82 offen offset:2048  lds
    buffer_load_dwordx4 v219, s[36:39], s82 offen offset:3072  lds
    s_addk_i32 m0, 0x4000
    s_add_u32 s83, s84, 0x0
    s_and_b32 s81, s83, 0x7000
    s_or_b32 s81, s81, 0x10000
    buffer_load_dwordx4 v212, s[28:31], s81 offen offset:0 nt lds
    buffer_load_dwordx4 v212, s[28:31], s81 offen offset:1024 nt lds
    buffer_load_dwordx4 v212, s[28:31], s81 offen offset:2048 nt lds
    buffer_load_dwordx4 v212, s[28:31], s81 offen offset:3072 nt lds
    s_addk_i32 m0, 0x1000
    s_addk_i32 s83, 0x1000
    s_and_b32 s81, s83, 0x7000
    s_or_b32 s81, s81, 0x10000
    buffer_load_dwordx4 v212, s[28:31], s81 offen offset:0 nt lds
    buffer_load_dwordx4 v212, s[28:31], s81 offen offset:1024 nt lds
    buffer_load_dwordx4 v212, s[28:31], s81 offen offset:2048 nt lds
    buffer_load_dwordx4 v212, s[28:31], s81 offen offset:3072 nt lds
    s_mov_b32 m0, 0x1d000
    s_addk_i32 s82, 0x4000
    buffer_load_dwordx4 v216, s[36:39], s82 offen offset:0  lds
    buffer_load_dwordx4 v217, s[36:39], s82 offen offset:1024  lds
    buffer_load_dwordx4 v218, s[36:39], s82 offen offset:2048  lds
    buffer_load_dwordx4 v219, s[36:39], s82 offen offset:3072  lds
    s_addk_i32 m0, 0x5000
    s_addk_i32 s83, 0x1000
    s_and_b32 s81, s83, 0x7000
    s_or_b32 s81, s81, 0x10000
    buffer_load_dwordx4 v212, s[28:31], s81 offen offset:0 nt lds
    buffer_load_dwordx4 v212, s[28:31], s81 offen offset:1024 nt lds
    buffer_load_dwordx4 v212, s[28:31], s81 offen offset:2048 nt lds
    buffer_load_dwordx4 v212, s[28:31], s81 offen offset:3072 nt lds
    s_addk_i32 m0, 0x1000
    s_addk_i32 s83, 0x1000
    s_and_b32 s81, s83, 0x7000
    s_or_b32 s81, s81, 0x10000
    buffer_load_dwordx4 v212, s[28:31], s81 offen offset:0 nt lds
    buffer_load_dwordx4 v212, s[28:31], s81 offen offset:1024 nt lds
    buffer_load_dwordx4 v212, s[28:31], s81 offen offset:2048 nt lds
    buffer_load_dwordx4 v212, s[28:31], s81 offen offset:3072 nt lds
    s_mov_b32 m0, 0x1e000
    s_addk_i32 s82, 0x4000
    buffer_load_dwordx4 v216, s[36:39], s82 offen offset:0  lds
    buffer_load_dwordx4 v217, s[36:39], s82 offen offset:1024  lds
    buffer_load_dwordx4 v218, s[36:39], s82 offen offset:2048  lds
    buffer_load_dwordx4 v219, s[36:39], s82 offen offset:3072  lds
    s_addk_i32 m0, 0x6000
    s_addk_i32 s83, 0x1000
    s_and_b32 s81, s83, 0x7000
    s_or_b32 s81, s81, 0x10000
    buffer_load_dwordx4 v212, s[28:31], s81 offen offset:0 nt lds
    buffer_load_dwordx4 v212, s[28:31], s81 offen offset:1024 nt lds
    buffer_load_dwordx4 v212, s[28:31], s81 offen offset:2048 nt lds
    buffer_load_dwordx4 v212, s[28:31], s81 offen offset:3072 nt lds
    s_addk_i32 m0, 0x1000
    s_addk_i32 s83, 0x1000
    s_and_b32 s81, s83, 0x7000
    s_or_b32 s81, s81, 0x10000
    buffer_load_dwordx4 v212, s[28:31], s81 offen offset:0 nt lds
    buffer_load_dwordx4 v212, s[28:31], s81 offen offset:1024 nt lds
    buffer_load_dwordx4 v212, s[28:31], s81 offen offset:2048 nt lds
    buffer_load_dwordx4 v212, s[28:31], s81 offen offset:3072 nt lds
    s_mov_b32 m0, 0x1f000
    s_addk_i32 s82, 0x4000
    buffer_load_dwordx4 v216, s[36:39], s82 offen offset:0  lds
    buffer_load_dwordx4 v217, s[36:39], s82 offen offset:1024  lds
    buffer_load_dwordx4 v218, s[36:39], s82 offen offset:2048  lds
    buffer_load_dwordx4 v219, s[36:39], s82 offen offset:3072  lds
    s_waitcnt vmcnt(40) lgkmcnt(0)
    s_barrier
    v_add_u32 v229, 0x10000, v228
    ds_read_b64_tr_b16 a[208:209], v229 offset:0
    ds_read_b64_tr_b16 a[210:211], v229 offset:2048
    ds_read_b64_tr_b16 a[212:213], v229 offset:4096
    ds_read_b64_tr_b16 a[214:215], v229 offset:6144
    ds_read_b64_tr_b16 a[216:217], v229 offset:8192
    ds_read_b64_tr_b16 a[218:219], v229 offset:10240
    ds_read_b64_tr_b16 a[220:221], v229 offset:12288
    ds_read_b64_tr_b16 a[222:223], v229 offset:14336
    s_addk_i32 m0, 0x7000
    s_addk_i32 s83, 0x1000
    s_and_b32 s81, s83, 0x7000
    s_or_b32 s81, s81, 0x10000
    buffer_load_dwordx4 v212, s[28:31], s81 offen offset:0 nt lds
    buffer_load_dwordx4 v212, s[28:31], s81 offen offset:1024 nt lds
    buffer_load_dwordx4 v212, s[28:31], s81 offen offset:2048 nt lds
    buffer_load_dwordx4 v212, s[28:31], s81 offen offset:3072 nt lds
    s_addk_i32 m0, 0x1000
    s_addk_i32 s83, 0x1000
    s_and_b32 s81, s83, 0x7000
    s_or_b32 s81, s81, 0x10000
    buffer_load_dwordx4 v212, s[28:31], s81 offen offset:0 nt lds
    buffer_load_dwordx4 v212, s[28:31], s81 offen offset:1024 nt lds
    buffer_load_dwordx4 v212, s[28:31], s81 offen offset:2048 nt lds
    buffer_load_dwordx4 v212, s[28:31], s81 offen offset:3072 nt lds
    s_mov_b32 m0, 0x4000
    s_add_u32 s81, s84, 0x0
    s_and_b32 s81, s81, 0x7000
    s_or_b32 s81, s81, 0x18000
    buffer_load_dwordx4 v214, s[28:31], s81 offen offset:0 nt lds
    buffer_load_dwordx4 v215, s[28:31], s81 offen offset:1024 nt lds
    s_mov_b32 m0, 0x4800
    s_add_u32 s81, s84, 0x1000
    s_and_b32 s81, s81, 0x7000
    s_or_b32 s81, s81, 0x18000
    buffer_load_dwordx4 v214, s[28:31], s81 offen offset:0 nt lds
    buffer_load_dwordx4 v215, s[28:31], s81 offen offset:1024 nt lds
    s_mov_b32 m0, 0x5000
    s_add_u32 s81, s84, 0x2000
    s_and_b32 s81, s81, 0x7000
    s_or_b32 s81, s81, 0x18000
    buffer_load_dwordx4 v214, s[28:31], s81 offen offset:0 nt lds
    buffer_load_dwordx4 v215, s[28:31], s81 offen offset:1024 nt lds
    s_mov_b32 m0, 0x5800
    s_add_u32 s81, s84, 0x3000
    s_and_b32 s81, s81, 0x7000
    s_or_b32 s81, s81, 0x18000
    buffer_load_dwordx4 v214, s[28:31], s81 offen offset:0 nt lds
    buffer_load_dwordx4 v215, s[28:31], s81 offen offset:1024 nt lds
    s_mov_b32 m0, 0x6000
    s_add_u32 s81, s84, 0x4000
    s_and_b32 s81, s81, 0x7000
    s_or_b32 s81, s81, 0x18000
    buffer_load_dwordx4 v214, s[28:31], s81 offen offset:0 nt lds
    buffer_load_dwordx4 v215, s[28:31], s81 offen offset:1024 nt lds
    s_mov_b32 m0, 0x6800
    s_add_u32 s81, s84, 0x5000
    s_and_b32 s81, s81, 0x7000
    s_or_b32 s81, s81, 0x18000
    buffer_load_dwordx4 v214, s[28:31], s81 offen offset:0 nt lds
    buffer_load_dwordx4 v215, s[28:31], s81 offen offset:1024 nt lds
    s_mov_b32 m0, 0x7000
    s_add_u32 s81, s84, 0x6000
    s_and_b32 s81, s81, 0x7000
    s_or_b32 s81, s81, 0x18000
    buffer_load_dwordx4 v214, s[28:31], s81 offen offset:0 nt lds
    buffer_load_dwordx4 v215, s[28:31], s81 offen offset:1024 nt lds
    s_mov_b32 m0, 0x7800
    s_add_u32 s81, s84, 0x7000
    s_and_b32 s81, s81, 0x7000
    s_or_b32 s81, s81, 0x18000
    buffer_load_dwordx4 v214, s[28:31], s81 offen offset:0 nt lds
    buffer_load_dwordx4 v215, s[28:31], s81 offen offset:1024 nt lds
    s_mov_b32 m0, 0x8000
    s_add_u32 s81, s84, 0x0
    s_and_b32 s81, s81, 0x7000
    s_or_b32 s81, s81, 0x18080
    buffer_load_dwordx4 v214, s[28:31], s81 offen offset:0 nt lds
    buffer_load_dwordx4 v215, s[28:31], s81 offen offset:1024 nt lds
    s_mov_b32 m0, 0x8800
    s_add_u32 s81, s84, 0x1000
    s_and_b32 s81, s81, 0x7000
    s_or_b32 s81, s81, 0x18080
    buffer_load_dwordx4 v214, s[28:31], s81 offen offset:0 nt lds
    buffer_load_dwordx4 v215, s[28:31], s81 offen offset:1024 nt lds
    s_mov_b32 m0, 0x9000
    s_add_u32 s81, s84, 0x2000
    s_and_b32 s81, s81, 0x7000
    s_or_b32 s81, s81, 0x18080
    buffer_load_dwordx4 v214, s[28:31], s81 offen offset:0 nt lds
    buffer_load_dwordx4 v215, s[28:31], s81 offen offset:1024 nt lds
    s_mov_b32 m0, 0x9800
    s_add_u32 s81, s84, 0x3000
    s_and_b32 s81, s81, 0x7000
    s_or_b32 s81, s81, 0x18080
    buffer_load_dwordx4 v214, s[28:31], s81 offen offset:0 nt lds
    buffer_load_dwordx4 v215, s[28:31], s81 offen offset:1024 nt lds
    s_mov_b32 m0, 0xa000
    s_add_u32 s81, s84, 0x4000
    s_and_b32 s81, s81, 0x7000
    s_or_b32 s81, s81, 0x18080
    buffer_load_dwordx4 v214, s[28:31], s81 offen offset:0 nt lds
    buffer_load_dwordx4 v215, s[28:31], s81 offen offset:1024 nt lds
    s_mov_b32 m0, 0xa800
    s_add_u32 s81, s84, 0x5000
    s_and_b32 s81, s81, 0x7000
    s_or_b32 s81, s81, 0x18080
    buffer_load_dwordx4 v214, s[28:31], s81 offen offset:0 nt lds
    buffer_load_dwordx4 v215, s[28:31], s81 offen offset:1024 nt lds
    s_mov_b32 m0, 0xb000
    s_add_u32 s81, s84, 0x6000
    s_and_b32 s81, s81, 0x7000
    s_or_b32 s81, s81, 0x18080
    buffer_load_dwordx4 v214, s[28:31], s81 offen offset:0 nt lds
    buffer_load_dwordx4 v215, s[28:31], s81 offen offset:1024 nt lds
    s_mov_b32 m0, 0xb800
    s_add_u32 s81, s84, 0x7000
    s_and_b32 s81, s81, 0x7000
    s_or_b32 s81, s81, 0x18080
    buffer_load_dwordx4 v214, s[28:31], s81 offen offset:0 nt lds
    buffer_load_dwordx4 v215, s[28:31], s81 offen offset:1024 nt lds
    s_mov_b32 m0, 0x0
    s_addk_i32 s82, 0x4000
    buffer_load_dwordx4 v216, s[36:39], s82 offen offset:0  lds
    buffer_load_dwordx4 v217, s[36:39], s82 offen offset:1024  lds
    buffer_load_dwordx4 v218, s[36:39], s82 offen offset:2048  lds
    buffer_load_dwordx4 v219, s[36:39], s82 offen offset:3072  lds
    s_addk_i32 m0, 0x1000
    s_addk_i32 s82, 0x4000
    buffer_load_dwordx4 v216, s[36:39], s82 offen offset:0  lds
    buffer_load_dwordx4 v217, s[36:39], s82 offen offset:1024  lds
    buffer_load_dwordx4 v218, s[36:39], s82 offen offset:2048  lds
    buffer_load_dwordx4 v219, s[36:39], s82 offen offset:3072  lds
    s_waitcnt vmcnt(40) lgkmcnt(0)
    s_barrier
    v_add_u32 v229, 0x1c000, v228
    ds_read_b64_tr_b16 a[224:225], v229 offset:0
    ds_read_b64_tr_b16 a[226:227], v229 offset:2048
    ds_read_b64_tr_b16 a[228:229], v229 offset:4096
    ds_read_b64_tr_b16 a[230:231], v229 offset:6144
    ds_read_b64_tr_b16 a[232:233], v229 offset:8192
    ds_read_b64_tr_b16 a[234:235], v229 offset:10240
    ds_read_b64_tr_b16 a[236:237], v229 offset:12288
    ds_read_b64_tr_b16 a[238:239], v229 offset:14336
    s_addk_i32 m0, 0x1000
    s_addk_i32 s82, 0x4000
    buffer_load_dwordx4 v216, s[36:39], s82 offen offset:0  lds
    buffer_load_dwordx4 v217, s[36:39], s82 offen offset:1024  lds
    buffer_load_dwordx4 v218, s[36:39], s82 offen offset:2048  lds
    buffer_load_dwordx4 v219, s[36:39], s82 offen offset:3072  lds
    s_addk_i32 m0, 0x1000
    s_addk_i32 s82, 0x4000
    buffer_load_dwordx4 v216, s[36:39], s82 offen offset:0  lds
    buffer_load_dwordx4 v217, s[36:39], s82 offen offset:1024  lds
    buffer_load_dwordx4 v218, s[36:39], s82 offen offset:2048  lds
    buffer_load_dwordx4 v219, s[36:39], s82 offen offset:3072  lds
    s_waitcnt vmcnt(32) lgkmcnt(0)
    s_barrier
    s_waitcnt vmcnt(20)
    s_barrier
    s_waitcnt vmcnt(16)
    s_barrier
    s_and_b32 s76, s2, 0xf8
    s_lshl_b32 s77, s40, 1
    s_add_u32 s78, s76, s77
    s_mul_i32 s76, s78, 24576
    s_mul_i32 s77, s41, 3072
    s_add_u32 s94, s76, s77
    s_add_u32 s95, s94, 24576
    s_lshl_b32 s78, s78, 8
    s_lshl_b32 s77, s41, 2
    s_add_u32 s96, s78, s77
    s_mov_b32 s78, 0
L_poll0:
    buffer_load_dword v235, v234, s[64:67], 0 offen offset:0 sc1
    s_add_u32 s78, s78, 1
    s_cmp_ge_u32 s78, 0x400000
    s_waitcnt vmcnt(0)
    s_cbranch_scc1 L_got0
    v_cmp_ne_u32 vcc, 1, v235
    s_nop 0
    s_cmp_lg_u64 vcc, 0
    s_cbranch_scc1 L_poll0
L_got0:
    s_mov_b32 m0, 0x10000
    s_add_u32 s76, s87, 0x0
    buffer_load_dwordx4 v240, s[56:59], s76 offen offset:0 sc1 lds
    buffer_load_dwordx4 v240, s[56:59], s76 offen offset:1024 sc1 lds
    buffer_load_dwordx4 v240, s[56:59], s76 offen offset:2048 sc1 lds
    buffer_load_dwordx4 v240, s[56:59], s76 offen offset:3072 sc1 lds
    s_mov_b32 m0, 0x12000
    s_add_u32 s76, s87, 0x2000
    buffer_load_dwordx4 v240, s[56:59], s76 offen offset:0 sc1 lds
    buffer_load_dwordx4 v240, s[56:59], s76 offen offset:1024 sc1 lds
    buffer_load_dwordx4 v240, s[56:59], s76 offen offset:2048 sc1 lds
    buffer_load_dwordx4 v240, s[56:59], s76 offen offset:3072 sc1 lds
    s_mov_b32 m0, 0x14000
    s_add_u32 s76, s87, 0x4000
    buffer_load_dwordx4 v240, s[56:59], s76 offen offset:0 sc1 lds
    buffer_load_dwordx4 v240, s[56:59], s76 offen offset:1024 sc1 lds
    buffer_load_dwordx4 v240, s[56:59], s76 offen offset:2048 sc1 lds
    buffer_load_dwordx4 v240, s[56:59], s76 offen offset:3072 sc1 lds
    s_mov_b32 m0, 0x16000
    s_add_u32 s76, s88, 0x0
    buffer_load_dwordx4 v240, s[56:59], s76 offen offset:0 sc1 lds
    buffer_load_dwordx4 v240, s[56:59], s76 offen offset:1024 sc1 lds
    buffer_load_dwordx4 v240, s[56:59], s76 offen offset:2048 sc1 lds
    buffer_load_dwordx4 v240, s[56:59], s76 offen offset:3072 sc1 lds
    s_mov_b32 m0, 0x18000
    s_add_u32 s76, s88, 0x2000
    buffer_load_dwordx4 v240, s[56:59], s76 offen offset:0 sc1 lds
    buffer_load_dwordx4 v240, s[56:59], s76 offen offset:1024 sc1 lds
    buffer_load_dwordx4 v240, s[56:59], s76 offen offset:2048 sc1 lds
    buffer_load_dwordx4 v240, s[56:59], s76 offen offset:3072 sc1 lds
    s_mov_b32 m0, 0x1a000
    s_add_u32 s76, s88, 0x4000
    buffer_load_dwordx4 v240, s[56:59], s76 offen offset:0 sc1 lds
    buffer_load_dwordx4 v240, s[56:59], s76 offen offset:1024 sc1 lds
    buffer_load_dwordx4 v240, s[56:59], s76 offen offset:2048 sc1 lds
    buffer_load_dwordx4 v240, s[56:59], s76 offen offset:3072 sc1 lds
    s_mov_b32 m0, 0x1c000
    s_add_u32 s76, s89, 0x0
    buffer_load_dwordx4 v240, s[56:59], s76 offen offset:0 sc1 lds
    buffer_load_dwordx4 v240, s[56:59], s76 offen offset:1024 sc1 lds
    buffer_load_dwordx4 v240, s[56:59], s76 offen offset:2048 sc1 lds
    buffer_load_dwordx4 v240, s[56:59], s76 offen offset:3072 sc1 lds
    s_mov_b32 m0, 0x1e000
    s_add_u32 s76, s89, 0x2000
    buffer_load_dwordx4 v240, s[56:59], s76 offen offset:0 sc1 lds
    buffer_load_dwordx4 v240, s[56:59], s76 offen offset:1024 sc1 lds
    buffer_load_dwordx4 v240, s[56:59], s76 offen offset:2048 sc1 lds
    buffer_load_dwordx4 v240, s[56:59], s76 offen offset:3072 sc1 lds
    s_mov_b32 m0, 0x20000
    s_add_u32 s76, s89, 0x4000
    buffer_load_dwordx4 v240, s[56:59], s76 offen offset:0 sc1 lds
    buffer_load_dwordx4 v240, s[56:59], s76 offen offset:1024 sc1 lds
    buffer_load_dwordx4 v240, s[56:59], s76 offen offset:2048 sc1 lds
    buffer_load_dwordx4 v240, s[56:59], s76 offen offset:3072 sc1 lds
    buffer_load_dword v235, v234, s[64:67], 0 offen offset:16 sc1
    s_mov_b32 s49, 1
    s_call_b64 s[22:23], L_bg
    s_branch L_bara
L_bg:
    s_waitcnt vmcnt(0)
    v_cmp_ne_u32 vcc, 1, v235
    s_nop 0
    s_cmp_lg_u64 vcc, 0
    s_cbranch_scc1 L_bg_again
L_bg_go:
    s_mov_b32 m0, 0x11000
    s_add_u32 s76, s87, 0x1000
    buffer_load_dwordx4 v240, s[56:59], s76 offen offset:0 sc1 lds
    buffer_load_dwordx4 v240, s[56:59], s76 offen offset:1024 sc1 lds
    buffer_load_dwordx4 v240, s[56:59], s76 offen offset:2048 sc1 lds
    buffer_load_dwordx4 v240, s[56:59], s76 offen offset:3072 sc1 lds
    s_mov_b32 m0, 0x13000
    s_add_u32 s76, s87, 0x3000
    buffer_load_dwordx4 v240, s[56:59], s76 offen offset:0 sc1 lds
    buffer_load_dwordx4 v240, s[56:59], s76 offen offset:1024 sc1 lds
    buffer_load_dwordx4 v240, s[56:59], s76 offen offset:2048 sc1 lds
    buffer_load_dwordx4 v240, s[56:59], s76 offen offset:3072 sc1 lds
    s_mov_b32 m0, 0x15000
    s_add_u32 s76, s87, 0x5000
    buffer_load_dwordx4 v240, s[56:59], s76 offen offset:0 sc1 lds
    buffer_load_dwordx4 v240, s[56:59], s76 offen offset:1024 sc1 lds
    buffer_load_dwordx4 v240, s[56:59], s76 offen offset:2048 sc1 lds
    buffer_load_dwordx4 v240, s[56:59], s76 offen offset:3072 sc1 lds
    s_mov_b32 m0, 0x17000
    s_add_u32 s76, s88, 0x1000
    buffer_load_dwordx4 v240, s[56:59], s76 offen offset:0 sc1 lds
    buffer_load_dwordx4 v240, s[56:59], s76 offen offset:1024 sc1 lds
    buffer_load_dwordx4 v240, s[56:59], s76 offen offset:2048 sc1 lds
    buffer_load_dwordx4 v240, s[56:59], s76 offen offset:3072 sc1 lds
    s_mov_b32 m0, 0x19000
    s_add_u32 s76, s88, 0x3000
    buffer_load_dwordx4 v240, s[56:59], s76 offen offset:0 sc1 lds
    buffer_load_dwordx4 v240, s[56:59], s76 offen offset:1024 sc1 lds
    buffer_load_dwordx4 v240, s[56:59], s76 offen offset:2048 sc1 lds
    buffer_load_dwordx4 v240, s[56:59], s76 offen offset:3072 sc1 lds
    s_mov_b32 m0, 0x1b000
    s_add_u32 s76, s88, 0x5000
    buffer_load_dwordx4 v240, s[56:59], s76 offen offset:0 sc1 lds
    buffer_load_dwordx4 v240, s[56:59], s76 offen offset:1024 sc1 lds
    buffer_load_dwordx4 v240, s[56:59], s76 offen offset:2048 sc1 lds
    buffer_load_dwordx4 v240, s[56:59], s76 offen offset:3072 sc1 lds
    s_mov_b32 m0, 0x1d000
    s_add_u32 s76, s89, 0x1000
    buffer_load_dwordx4 v240, s[56:59], s76 offen offset:0 sc1 lds
    buffer_load_dwordx4 v240, s[56:59], s76 offen offset:1024 sc1 lds
    buffer_load_dwordx4 v240, s[56:59], s76 offen offset:2048 sc1 lds
    buffer_load_dwordx4 v240, s[56:59], s76 offen offset:3072 sc1 lds
    s_mov_b32 m0, 0x1f000
    s_add_u32 s76, s89, 0x3000
    buffer_load_dwordx4 v240, s[56:59], s76 offen offset:0 sc1 lds
    buffer_load_dwordx4 v240, s[56:59], s76 offen offset:1024 sc1 lds
    buffer_load_dwordx4 v240, s[56:59], s76 offen offset:2048 sc1 lds
    buffer_load_dwordx4 v240, s[56:59], s76 offen offset:3072 sc1 lds
    s_mov_b32 m0, 0x21000
    s_add_u32 s76, s89, 0x5000
    buffer_load_dwordx4 v240, s[56:59], s76 offen offset:0 sc1 lds
    buffer_load_dwordx4 v240, s[56:59], s76 offen offset:1024 sc1 lds
    buffer_load_dwordx4 v240, s[56:59], s76 offen offset:2048 sc1 lds
    buffer_load_dwordx4 v240, s[56:59], s76 offen offset:3072 sc1 lds
    s_mov_b32 s49, 0
    s_setpc_b64 s[22:23]
L_bg_again:
    buffer_load_dword v235, v234, s[64:67], 0 offen offset:16 sc1
    s_setpc_b64 s[22:23]
.p2align 6
L_compute:
    s_waitcnt lgkmcnt(0)
    s_mov_b32 s56, s18
    s_mov_b32 s57, s19
    s_mov_b32 s58, 0x600000
    s_mov_b32 s59, 0x20000
    s_add_u32 s60, s18, 0x600000
    s_addc_u32 s61, s19, 0
    s_mov_b32 s62, 0x600000
    s_mov_b32 s63, 0x20000
    s_add_u32 s64, s18, 0xc00000
    s_addc_u32 s65, s19, 0
    s_mov_b32 s66, 0x10000
    s_mov_b32 s67, 0x20000
    s_mov_b32 s72, s16
    s_mov_b32 s73, s17
    s_mov_b32 s74, 0x100
    s_mov_b32 s75, 0x20000
    s_mul_i32 s76, s43, 98304
    s_add_u32 s68, s14, s76
    s_addc_u32 s69, s15, 0
    s_mov_b32 s70, 0x18000
    s_mov_b32 s71, 0x20000
    v_lshlrev_b32 v240, 4, v1
    v_mov_b32 v241, 0xc000
    v_add_u32 v242, 0x10000, v240
    v_add_u32 v243, 0x1c000, v240
    v_mov_b32 v248, 1
    v_min_u32 v249, 1, v1
    v_lshlrev_b32 v249, 30, v249
    v_lshrrev_b32 v230, 5, v1
    v_mul_u32_u24 v230, 8, v230
    v_bfe_u32 v231, v1, 2, 2
    v_add_u32 v230, v230, v231
    v_lshlrev_b32 v230, 8, v230
    v_bfe_u32 v232, v1, 4, 1
    v_lshl_add_u32 v230, v232, 5, v230
    v_and_b32 v232, 1, v1
    v_lshl_add_u32 v230, v232, 4, v230
    v_bfe_u32 v232, v1, 1, 1
    v_lshl_add_u32 v230, v232, 3, v230
    v_xor_b32 v232, 0, v231
    v_lshl_add_u32 v196, v232, 6, v230
    v_xor_b32 v232, 1, v231
    v_lshl_add_u32 v197, v232, 6, v230
    v_xor_b32 v232, 2, v231
    v_lshl_add_u32 v198, v232, 6, v230
    v_xor_b32 v232, 3, v231
    v_lshl_add_u32 v199, v232, 6, v230
    v_and_b32 v230, 31, v1
    s_lshl_b32 s76, s40, 5
    v_add_u32 v230, s76, v230
    v_bfe_u32 v231, v230, 1, 3
    v_lshrrev_b32 v232, 5, v1
    v_xor_b32 v231, v231, v232
    v_lshlrev_b32 v231, 4, v231
    v_lshl_add_u32 v200, v230, 7, v231
    v_and_b32 v230, 31, v1
    v_and_b32 v231, 15, v1
    v_xor_b32 v231, v231, v232
    v_lshlrev_b32 v231, 4, v231
    v_lshl_add_u32 v209, v230, 8, v231
    v_add_u32 v209, 0x4000, v209
    v_lshrrev_b32 v230, 5, v1
    v_mul_u32_u24 v230, 4, v230
    v_bfe_u32 v231, v1, 2, 2
    v_add_u32 v230, v230, v231
    v_lshlrev_b32 v230, 8, v230
    v_bfe_u32 v232, v1, 4, 1
    v_lshl_add_u32 v230, v232, 5, v230
    v_and_b32 v232, 3, v1
    v_lshl_add_u32 v230, v232, 3, v230
    v_xor_b32 v232, 0, v231
    v_lshl_add_u32 v218, v232, 6, v230
    v_xor_b32 v232, 1, v231
    v_lshl_add_u32 v219, v232, 6, v230
    v_xor_b32 v232, 2, v231
    v_lshl_add_u32 v220, v232, 6, v230
    v_xor_b32 v232, 3, v231
    v_lshl_add_u32 v221, v232, 6, v230
    v_add_u32 v218, 0x4000, v218
    v_add_u32 v219, 0x4000, v219
    v_add_u32 v220, 0x4000, v220
    v_add_u32 v221, 0x4000, v221
    v_lshrrev_b32 v230, 5, v1
    v_bfe_u32 v231, v1, 2, 2
    v_lshl_add_u32 v230, v230, 2, v231
    v_lshlrev_b32 v230, 7, v230
    v_bfe_u32 v232, v1, 4, 1
    v_lshl_add_u32 v230, v232, 5, v230
    v_and_b32 v232, 3, v1
    v_lshl_add_u32 v230, v232, 3, v230
    v_bfe_u32 v231, v1, 3, 1
    v_lshl_add_u32 v236, v231, 6, v230
    v_add_u32 v236, 0x4000, v236
    v_xor_b32 v237, 64, v236
    v_lshrrev_b32 v230, 5, v1
    v_mul_u32_u24 v230, 4, v230
    v_bfe_u32 v231, v1, 2, 2
    v_add_u32 v230, v230, v231
    v_lshlrev_b32 v230, 8, v230
    v_bfe_u32 v232, v1, 4, 1
    v_lshl_add_u32 v230, v232, 5, v230
    v_and_b32 v232, 1, v1
    v_lshl_add_u32 v230, v232, 4, v230
    v_bfe_u32 v232, v1, 1, 1
    v_lshl_add_u32 v230, v232, 3, v230
    v_xor_b32 v232, s40, v231
    v_lshl_add_u32 v238, v232, 6, v230
    v_xor_b32 v232, 3, v231
    v_lshl_add_u32 v246, v232, 6, v230
    v_mov_b64 v[100:101], 0
    v_mov_b64 v[102:103], 0
    v_mov_b64 v[104:105], 0
    v_mov_b64 v[106:107], 0
    v_mov_b64 v[108:109], 0
    v_mov_b64 v[110:111], 0
    v_mov_b64 v[112:113], 0
    v_mov_b64 v[114:115], 0
    v_mov_b64 v[116:117], 0
    v_mov_b64 v[118:119], 0
    v_mov_b64 v[120:121], 0
    v_mov_b64 v[122:123], 0
    v_mov_b64 v[124:125], 0
    v_mov_b64 v[126:127], 0
    v_mov_b64 v[128:129], 0
    v_mov_b64 v[130:131], 0
    v_mov_b64 v[132:133], 0
    v_mov_b64 v[134:135], 0
    v_mov_b64 v[136:137], 0
    v_mov_b64 v[138:139], 0
    v_mov_b64 v[140:141], 0
    v_mov_b64 v[142:143], 0
    v_mov_b64 v[144:145], 0
    v_mov_b64 v[146:147], 0
    v_mov_b64 v[148:149], 0
    v_mov_b64 v[150:151], 0
    v_mov_b64 v[152:153], 0
    v_mov_b64 v[154:155], 0
    v_mov_b64 v[156:157], 0
    v_mov_b64 v[158:159], 0
    v_mov_b64 v[160:161], 0
    v_mov_b64 v[162:163], 0
    v_mov_b64 v[36:37], 0
    v_mov_b64 v[38:39], 0
    v_mov_b64 v[40:41], 0
    v_mov_b64 v[42:43], 0
    v_mov_b64 v[44:45], 0
    v_mov_b64 v[46:47], 0
    v_mov_b64 v[48:49], 0
    v_mov_b64 v[50:51], 0
    v_mov_b64 v[52:53], 0
    v_mov_b64 v[54:55], 0
    v_mov_b64 v[56:57], 0
    v_mov_b64 v[58:59], 0
    v_mov_b64 v[60:61], 0
    v_mov_b64 v[62:63], 0
    v_mov_b64 v[64:65], 0
    v_mov_b64 v[66:67], 0
    v_mov_b64 v[68:69], 0
    v_mov_b64 v[70:71], 0
    v_mov_b64 v[72:73], 0
    v_mov_b64 v[74:75], 0
    v_mov_b64 v[76:77], 0
    v_mov_b64 v[78:79], 0
    v_mov_b64 v[80:81], 0
    v_mov_b64 v[82:83], 0
    v_mov_b64 v[84:85], 0
    v_mov_b64 v[86:87], 0
    v_mov_b64 v[88:89], 0
    v_mov_b64 v[90:91], 0
    v_mov_b64 v[92:93], 0
    v_mov_b64 v[94:95], 0
    v_mov_b64 v[96:97], 0
    v_mov_b64 v[98:99], 0
    v_mov_b32 v226, 0xff800000
    v_mov_b64 v[228:229], 0
    v_mov_b32 v234, 0
    s_mov_b32 s50, 0x3e0293ee
    s_mov_b32 s51, 0x3e0293ee
    s_mov_b32 s47, 0
    s_mov_b32 s52, 0x1c000
    s_mov_b32 s53, 0x10000
    s_mov_b32 s54, 0x0
    s_mov_b32 s48, 0
    v_add_u32 v201, s47, v196
    v_add_u32 v202, s47, v197
    v_add_u32 v203, s47, v198
    v_add_u32 v204, s47, v199
    v_add_u32 v205, s47, v200
    v_xor_b32 v206, 32, v205
    v_xor_b32 v207, 64, v205
    v_xor_b32 v208, 96, v205
    s_barrier
    ds_read_b128 a[32:35], v205 offset:16384
    ds_read_b64_tr_b16 a[0:1], v201 offset:0
    ds_read_b64_tr_b16 a[2:3], v201 offset:1024
    ds_read_b64_tr_b16 a[4:5], v202 offset:0
    ds_read_b64_tr_b16 a[6:7], v202 offset:1024
    ds_read_b64_tr_b16 a[8:9], v203 offset:0
    ds_read_b64_tr_b16 a[10:11], v203 offset:1024
    ds_read_b64_tr_b16 a[12:13], v204 offset:0
    ds_read_b64_tr_b16 a[14:15], v204 offset:1024
.p2align 6
L_qp:
    s_waitcnt lgkmcnt(6)
    v_mfma_f32_32x32x16_bf16 v[100:115], a[0:3], a[32:35], v[100:115]
    ds_read_b128 a[36:39], v206 offset:16384
    ds_read_b64_tr_b16 a[16:17], v201 offset:4096
    ds_read_b64_tr_b16 a[18:19], v201 offset:5120
    s_waitcnt lgkmcnt(7)
    v_mfma_f32_32x32x16_bf16 v[116:131], a[4:7], a[32:35], v[116:131]
    ds_read_b64_tr_b16 a[20:21], v202 offset:4096
    ds_read_b64_tr_b16 a[22:23], v202 offset:5120
    ds_read_b64_tr_b16 a[24:25], v203 offset:4096
    s_waitcnt lgkmcnt(8)
    v_mfma_f32_32x32x16_bf16 v[132:147], a[8:11], a[32:35], v[132:147]
    ds_read_b64_tr_b16 a[26:27], v203 offset:5120
    ds_read_b64_tr_b16 a[28:29], v204 offset:4096
    ds_read_b64_tr_b16 a[30:31], v204 offset:5120
    s_waitcnt lgkmcnt(9)
    v_mfma_f32_32x32x16_bf16 v[148:163], a[12:15], a[32:35], v[148:163]
    s_waitcnt lgkmcnt(6)
    v_mfma_f32_32x32x16_bf16 v[100:115], a[16:19], a[36:39], v[100:115]
    ds_read_b128 a[32:35], v207 offset:16384
    ds_read_b64_tr_b16 a[0:1], v201 offset:8192
    ds_read_b64_tr_b16 a[2:3], v201 offset:9216
    s_waitcnt lgkmcnt(7)
    v_mfma_f32_32x32x16_bf16 v[116:131], a[20:23], a[36:39], v[116:131]
    ds_read_b64_tr_b16 a[4:5], v202 offset:8192
    ds_read_b64_tr_b16 a[6:7], v202 offset:9216
    ds_read_b64_tr_b16 a[8:9], v203 offset:8192
    s_waitcnt lgkmcnt(8)
    v_mfma_f32_32x32x16_bf16 v[132:147], a[24:27], a[36:39], v[132:147]
    ds_read_b64_tr_b16 a[10:11], v203 offset:9216
    ds_read_b64_tr_b16 a[12:13], v204 offset:8192
    ds_read_b64_tr_b16 a[14:15], v204 offset:9216
    s_waitcnt lgkmcnt(9)
    v_mfma_f32_32x32x16_bf16 v[148:163], a[28:31], a[36:39], v[148:163]
    s_waitcnt lgkmcnt(6)
    v_mfma_f32_32x32x16_bf16 v[100:115], a[0:3], a[32:35], v[100:115]
    ds_read_b128 a[36:39], v208 offset:16384
    ds_read_b64_tr_b16 a[16:17], v201 offset:12288
    ds_read_b64_tr_b16 a[18:19], v201 offset:13312
    s_waitcnt lgkmcnt(7)
    v_mfma_f32_32x32x16_bf16 v[116:131], a[4:7], a[32:35], v[116:131]
    ds_read_b64_tr_b16 a[20:21], v202 offset:12288
    ds_read_b64_tr_b16 a[22:23], v202 offset:13312
    ds_read_b64_tr_b16 a[24:25], v203 offset:12288
    s_waitcnt lgkmcnt(8)
    v_mfma_f32_32x32x16_bf16 v[132:147], a[8:11], a[32:35], v[132:147]
    ds_read_b64_tr_b16 a[26:27], v203 offset:13312
    ds_read_b64_tr_b16 a[28:29], v204 offset:12288
    ds_read_b64_tr_b16 a[30:31], v204 offset:13312
    s_waitcnt lgkmcnt(9)
    v_mfma_f32_32x32x16_bf16 v[148:163], a[12:15], a[32:35], v[148:163]
    s_add_u32 s47, s47, 0x7000
    s_cmp_eq_u32 s47, 0x23000
    s_cselect_b32 s47, 0, s47
    v_add_u32 v201, s47, v196
    v_add_u32 v202, s47, v197
    v_add_u32 v205, s47, v200
    s_add_u32 s48, s48, 1
    s_cmp_eq_u32 s48, 8
    s_cbranch_scc1 L_qp_last
    s_waitcnt lgkmcnt(6)
    v_mfma_f32_32x32x16_bf16 v[100:115], a[16:19], a[36:39], v[100:115]
    s_barrier
    v_add_u32 v203, s47, v198
    v_add_u32 v204, s47, v199
    ds_read_b128 a[32:35], v205 offset:16384
    ds_read_b64_tr_b16 a[0:1], v201 offset:0
    ds_read_b64_tr_b16 a[2:3], v201 offset:1024
    s_waitcnt lgkmcnt(7)
    v_mfma_f32_32x32x16_bf16 v[116:131], a[20:23], a[36:39], v[116:131]
    ds_read_b64_tr_b16 a[4:5], v202 offset:0
    ds_read_b64_tr_b16 a[6:7], v202 offset:1024
    ds_read_b64_tr_b16 a[8:9], v203 offset:0
    v_xor_b32 v206, 32, v205
    v_xor_b32 v207, 64, v205
    v_xor_b32 v208, 96, v205
    s_waitcnt lgkmcnt(8)
    v_mfma_f32_32x32x16_bf16 v[132:147], a[24:27], a[36:39], v[132:147]
    ds_read_b64_tr_b16 a[10:11], v203 offset:1024
    ds_read_b64_tr_b16 a[12:13], v204 offset:0
    ds_read_b64_tr_b16 a[14:15], v204 offset:1024
    s_waitcnt lgkmcnt(9)
    v_mfma_f32_32x32x16_bf16 v[148:163], a[28:31], a[36:39], v[148:163]
    s_branch L_qp
L_qp_last:
    s_waitcnt lgkmcnt(6)
    v_mfma_f32_32x32x16_bf16 v[100:115], a[16:19], a[36:39], v[100:115]
    s_waitcnt lgkmcnt(4)
    v_mfma_f32_32x32x16_bf16 v[116:131], a[20:23], a[36:39], v[116:131]
    s_waitcnt lgkmcnt(2)
    v_mfma_f32_32x32x16_bf16 v[132:147], a[24:27], a[36:39], v[132:147]
    s_waitcnt lgkmcnt(0)
    v_mfma_f32_32x32x16_bf16 v[148:163], a[28:31], a[36:39], v[148:163]
    s_mov_b32 s48, 0
    v_add_u32 v210, s52, v209
    v_xor_b32 v211, 32, v210
    v_xor_b32 v212, 64, v210
    v_xor_b32 v213, 96, v210
    v_xor_b32 v214, 128, v210
    v_xor_b32 v215, 160, v210
    v_xor_b32 v216, 192, v210
    v_xor_b32 v217, 224, v210
    s_barrier
    ds_read_b128 a[0:3], v210 offset:0
    ds_read_b128 a[4:7], v211 offset:0
    ds_read_b128 a[8:11], v212 offset:0
    ds_read_b128 a[12:15], v213 offset:0
    ds_read_b128 a[16:19], v214 offset:0
    ds_read_b128 a[20:23], v215 offset:0
    ds_read_b128 a[24:27], v216 offset:0
    ds_read_b128 a[28:31], v217 offset:0
    v_cvt_pk_bf16_f32 v4, v100, v101
    v_cvt_pk_bf16_f32 v5, v102, v103
    v_cvt_pk_bf16_f32 v6, v104, v105
    v_cvt_pk_bf16_f32 v7, v106, v107
    v_cvt_pk_bf16_f32 v8, v108, v109
    v_cvt_pk_bf16_f32 v9, v110, v111
    v_cvt_pk_bf16_f32 v10, v112, v113
    v_cvt_pk_bf16_f32 v11, v114, v115
    v_cvt_pk_bf16_f32 v12, v116, v117
    v_cvt_pk_bf16_f32 v13, v118, v119
    v_cvt_pk_bf16_f32 v14, v120, v121
    v_cvt_pk_bf16_f32 v15, v122, v123
    v_cvt_pk_bf16_f32 v16, v124, v125
    v_cvt_pk_bf16_f32 v17, v126, v127
    v_cvt_pk_bf16_f32 v18, v128, v129
    v_cvt_pk_bf16_f32 v19, v130, v131
    v_cvt_pk_bf16_f32 v20, v132, v133
    v_cvt_pk_bf16_f32 v21, v134, v135
    v_cvt_pk_bf16_f32 v22, v136, v137
    v_cvt_pk_bf16_f32 v23, v138, v139
    v_cvt_pk_bf16_f32 v24, v140, v141
    v_cvt_pk_bf16_f32 v25, v142, v143
    v_cvt_pk_bf16_f32 v26, v144, v145
    v_cvt_pk_bf16_f32 v27, v146, v147
    v_cvt_pk_bf16_f32 v28, v148, v149
    v_cvt_pk_bf16_f32 v29, v150, v151
    v_cvt_pk_bf16_f32 v30, v152, v153
    v_cvt_pk_bf16_f32 v31, v154, v155
    v_cvt_pk_bf16_f32 v32, v156, v157
    v_cvt_pk_bf16_f32 v33, v158, v159
    v_cvt_pk_bf16_f32 v34, v160, v161
    v_cvt_pk_bf16_f32 v35, v162, v163
.p2align 6
L_att:
    s_waitcnt lgkmcnt(6)
    v_mfma_f32_32x32x16_bf16 v[100:115], a[0:3], v[4:7], 0
    ds_read_b128 a[32:35], v210 offset:8192
    v_mul_f32 v36, v234, v36
    v_mul_f32 v37, v234, v37
    v_mul_f32 v38, v234, v38
    v_mfma_f32_32x32x16_bf16 v[100:115], a[4:7], v[8:11], v[100:115]
    ds_read_b128 a[36:39], v211 offset:8192
    v_mul_f32 v39, v234, v39
    v_mul_f32 v40, v234, v40
    v_mul_f32 v41, v234, v41
    s_waitcnt lgkmcnt(6)
    v_mfma_f32_32x32x16_bf16 v[100:115], a[8:11], v[12:15], v[100:115]
    ds_read_b128 a[40:43], v212 offset:8192
    v_mul_f32 v42, v234, v42
    v_mul_f32 v43, v234, v43
    v_mul_f32 v44, v234, v44
    v_mfma_f32_32x32x16_bf16 v[100:115], a[12:15], v[16:19], v[100:115]
    ds_read_b128 a[44:47], v213 offset:8192
    v_mul_f32 v45, v234, v45
    v_mul_f32 v46, v234, v46
    v_mul_f32 v47, v234, v47
    s_waitcnt lgkmcnt(6)
    v_mfma_f32_32x32x16_bf16 v[100:115], a[16:19], v[20:23], v[100:115]
    ds_read_b128 a[48:51], v214 offset:8192
    v_mul_f32 v48, v234, v48
    v_mul_f32 v49, v234, v49
    v_mul_f32 v50, v234, v50
    v_mfma_f32_32x32x16_bf16 v[100:115], a[20:23], v[24:27], v[100:115]
    ds_read_b128 a[52:55], v215 offset:8192
    v_mul_f32 v51, v234, v51
    v_mul_f32 v52, v234, v52
    v_mul_f32 v53, v234, v53
    s_waitcnt lgkmcnt(6)
    v_mfma_f32_32x32x16_bf16 v[100:115], a[24:27], v[28:31], v[100:115]
    ds_read_b128 a[56:59], v216 offset:8192
    v_mul_f32 v54, v234, v54
    v_mul_f32 v55, v234, v55
    v_mul_f32 v56, v234, v56
    v_mfma_f32_32x32x16_bf16 v[100:115], a[28:31], v[32:35], v[100:115]
    ds_read_b128 a[60:63], v217 offset:8192
    v_mul_f32 v57, v234, v57
    v_mul_f32 v58, v234, v58
    v_mul_f32 v59, v234, v59
    s_waitcnt lgkmcnt(6)
    v_mfma_f32_32x32x16_bf16 v[116:131], a[32:35], v[4:7], 0
    ds_read_b128 a[0:3], v210 offset:16384
    v_mul_f32 v60, v234, v60
    v_mul_f32 v61, v234, v61
    v_mul_f32 v62, v234, v62
    v_mfma_f32_32x32x16_bf16 v[116:131], a[36:39], v[8:11], v[116:131]
    ds_read_b128 a[4:7], v211 offset:16384
    v_mul_f32 v63, v234, v63
    v_mul_f32 v64, v234, v64
    v_mul_f32 v65, v234, v65
    s_waitcnt lgkmcnt(6)
    v_mfma_f32_32x32x16_bf16 v[116:131], a[40:43], v[12:15], v[116:131]
    ds_read_b128 a[8:11], v212 offset:16384
    v_mul_f32 v66, v234, v66
    v_mul_f32 v67, v234, v67
    v_mul_f32 v68, v234, v68
    v_mfma_f32_32x32x16_bf16 v[116:131], a[44:47], v[16:19], v[116:131]
    ds_read_b128 a[12:15], v213 offset:16384
    v_mul_f32 v69, v234, v69
    v_mul_f32 v70, v234, v70
    v_mul_f32 v71, v234, v71
    s_waitcnt lgkmcnt(6)
    v_mfma_f32_32x32x16_bf16 v[116:131], a[48:51], v[20:23], v[116:131]
    ds_read_b128 a[16:19], v214 offset:16384
    v_max3_f32 v230, v100, v101, v226
    v_max3_f32 v230, v102, v103, v230
    v_mul_f32 v72, v234, v72
    v_mfma_f32_32x32x16_bf16 v[116:131], a[52:55], v[24:27], v[116:131]
    ds_read_b128 a[20:23], v215 offset:16384
    v_max3_f32 v230, v104, v105, v230
    v_max3_f32 v230, v106, v107, v230
    v_mul_f32 v73, v234, v73
    s_waitcnt lgkmcnt(6)
    v_mfma_f32_32x32x16_bf16 v[116:131], a[56:59], v[28:31], v[116:131]
    ds_read_b128 a[24:27], v216 offset:16384
    v_max3_f32 v230, v108, v109, v230
    v_max3_f32 v230, v110, v111, v230
    v_mul_f32 v74, v234, v74
    v_mfma_f32_32x32x16_bf16 v[116:131], a[60:63], v[32:35], v[116:131]
    ds_read_b128 a[28:31], v217 offset:16384
    v_max3_f32 v230, v112, v113, v230
    v_max3_f32 v230, v114, v115, v230
    v_mul_f32 v75, v234, v75
    s_waitcnt lgkmcnt(6)
    v_mfma_f32_32x32x16_bf16 v[132:147], a[0:3], v[4:7], 0
    ds_read_b128 a[32:35], v210 offset:24576
    v_mul_f32 v76, v234, v76
    v_mul_f32 v77, v234, v77
    v_mul_f32 v78, v234, v78
    v_mfma_f32_32x32x16_bf16 v[132:147], a[4:7], v[8:11], v[132:147]
    ds_read_b128 a[36:39], v211 offset:24576
    v_mul_f32 v79, v234, v79
    v_mul_f32 v80, v234, v80
    v_mul_f32 v81, v234, v81
    s_waitcnt lgkmcnt(6)
    v_mfma_f32_32x32x16_bf16 v[132:147], a[8:11], v[12:15], v[132:147]
    ds_read_b128 a[40:43], v212 offset:24576
    v_mul_f32 v82, v234, v82
    v_mul_f32 v83, v234, v83
    v_mul_f32 v84, v234, v84
    v_mfma_f32_32x32x16_bf16 v[132:147], a[12:15], v[16:19], v[132:147]
    ds_read_b128 a[44:47], v213 offset:24576
    v_mul_f32 v85, v234, v85
    v_mul_f32 v86, v234, v86
    v_mul_f32 v87, v234, v87
    s_waitcnt lgkmcnt(6)
    v_mfma_f32_32x32x16_bf16 v[132:147], a[16:19], v[20:23], v[132:147]
    ds_read_b128 a[48:51], v214 offset:24576
    v_max3_f32 v230, v116, v117, v230
    v_max3_f32 v230, v118, v119, v230
    v_mul_f32 v88, v234, v88
    v_mfma_f32_32x32x16_bf16 v[132:147], a[20:23], v[24:27], v[132:147]
    ds_read_b128 a[52:55], v215 offset:24576
    v_max3_f32 v230, v120, v121, v230
    v_max3_f32 v230, v122, v123, v230
    v_mul_f32 v89, v234, v89
    s_waitcnt lgkmcnt(6)
    v_mfma_f32_32x32x16_bf16 v[132:147], a[24:27], v[28:31], v[132:147]
    ds_read_b128 a[56:59], v216 offset:24576
    v_max3_f32 v230, v124, v125, v230
    v_max3_f32 v230, v126, v127, v230
    v_mul_f32 v90, v234, v90
    v_mfma_f32_32x32x16_bf16 v[132:147], a[28:31], v[32:35], v[132:147]
    ds_read_b128 a[60:63], v217 offset:24576
    v_max3_f32 v230, v128, v129, v230
    v_max3_f32 v230, v130, v131, v230
    v_mul_f32 v91, v234, v91
    s_waitcnt lgkmcnt(6)
    v_mfma_f32_32x32x16_bf16 v[148:163], a[32:35], v[4:7], 0
    v_mul_f32 v92, v234, v92
    v_mul_f32 v93, v234, v93
    v_mul_f32 v94, v234, v94
    v_mul_f32 v95, v234, v95
    v_mfma_f32_32x32x16_bf16 v[148:163], a[36:39], v[8:11], v[148:163]
    v_mul_f32 v96, v234, v96
    v_mul_f32 v97, v234, v97
    v_mul_f32 v98, v234, v98
    v_mul_f32 v99, v234, v99
    s_waitcnt lgkmcnt(4)
    v_mfma_f32_32x32x16_bf16 v[148:163], a[40:43], v[12:15], v[148:163]
    v_add_u32 v239, s52, v238
    v_add_u32 v247, s52, v246
    v_add_u32 v222, s53, v218
    v_add_u32 v223, s53, v219
    v_mfma_f32_32x32x16_bf16 v[148:163], a[44:47], v[16:19], v[148:163]
    v_add_u32 v224, s53, v220
    v_add_u32 v225, s53, v221
    v_add_u32 v210, s54, v209
    v_xor_b32 v211, 32, v210
    s_waitcnt lgkmcnt(2)
    v_mfma_f32_32x32x16_bf16 v[148:163], a[48:51], v[20:23], v[148:163]
    v_max3_f32 v230, v132, v133, v230
    v_max3_f32 v230, v134, v135, v230
    v_xor_b32 v212, 64, v210
    v_xor_b32 v213, 96, v210
    v_mfma_f32_32x32x16_bf16 v[148:163], a[52:55], v[24:27], v[148:163]
    v_max3_f32 v230, v136, v137, v230
    v_max3_f32 v230, v138, v139, v230
    v_xor_b32 v214, 128, v210
    v_xor_b32 v215, 160, v210
    s_waitcnt lgkmcnt(0)
    v_mfma_f32_32x32x16_bf16 v[148:163], a[56:59], v[28:31], v[148:163]
    v_max3_f32 v230, v140, v141, v230
    v_max3_f32 v230, v142, v143, v230
    v_xor_b32 v216, 192, v210
    v_xor_b32 v217, 224, v210
    v_mfma_f32_32x32x16_bf16 v[148:163], a[60:63], v[32:35], v[148:163]
    v_max3_f32 v230, v144, v145, v230
    v_max3_f32 v230, v146, v147, v230
    s_cmp_lg_u32 s48, 0
    s_cbranch_scc1 L_woa1
    ds_read_b64_tr_b16 a[128:129], v239 offset:0
    ds_read_b64_tr_b16 a[130:131], v239 offset:2048
    ds_read_b64_tr_b16 a[132:133], v239 offset:4096
    ds_read_b64_tr_b16 a[134:135], v239 offset:6144
    ds_read_b64_tr_b16 a[136:137], v239 offset:8192
    ds_read_b64_tr_b16 a[138:139], v239 offset:10240
    ds_read_b64_tr_b16 a[140:141], v239 offset:12288
    ds_read_b64_tr_b16 a[142:143], v239 offset:14336
    ds_read_b64_tr_b16 a[96:97], v247 offset:0
    ds_read_b64_tr_b16 a[98:99], v247 offset:2048
    ds_read_b64_tr_b16 a[100:101], v247 offset:4096
    ds_read_b64_tr_b16 a[102:103], v247 offset:6144
    ds_read_b64_tr_b16 a[104:105], v247 offset:8192
    ds_read_b64_tr_b16 a[106:107], v247 offset:10240
    ds_read_b64_tr_b16 a[108:109], v247 offset:12288
    ds_read_b64_tr_b16 a[110:111], v247 offset:14336
    s_branch L_woadone
L_woa1:
    s_cmp_lg_u32 s48, 1
    s_cbranch_scc1 L_woa2
    ds_read_b64_tr_b16 a[144:145], v239 offset:0
    ds_read_b64_tr_b16 a[146:147], v239 offset:2048
    ds_read_b64_tr_b16 a[148:149], v239 offset:4096
    ds_read_b64_tr_b16 a[150:151], v239 offset:6144
    ds_read_b64_tr_b16 a[152:153], v239 offset:8192
    ds_read_b64_tr_b16 a[154:155], v239 offset:10240
    ds_read_b64_tr_b16 a[156:157], v239 offset:12288
    ds_read_b64_tr_b16 a[158:159], v239 offset:14336
    ds_read_b64_tr_b16 a[112:113], v247 offset:0
    ds_read_b64_tr_b16 a[114:115], v247 offset:2048
    ds_read_b64_tr_b16 a[116:117], v247 offset:4096
    ds_read_b64_tr_b16 a[118:119], v247 offset:6144
    ds_read_b64_tr_b16 a[120:121], v247 offset:8192
    ds_read_b64_tr_b16 a[122:123], v247 offset:10240
    ds_read_b64_tr_b16 a[124:125], v247 offset:12288
    ds_read_b64_tr_b16 a[126:127], v247 offset:14336
    s_branch L_woadone
L_woa2:
    s_cmp_lg_u32 s48, 2
    s_cbranch_scc1 L_woa3
    ds_read_b64_tr_b16 a[176:177], v239 offset:0
    ds_read_b64_tr_b16 a[178:179], v239 offset:2048
    ds_read_b64_tr_b16 a[180:181], v239 offset:4096
    ds_read_b64_tr_b16 a[182:183], v239 offset:6144
    ds_read_b64_tr_b16 a[184:185], v239 offset:8192
    ds_read_b64_tr_b16 a[186:187], v239 offset:10240
    ds_read_b64_tr_b16 a[188:189], v239 offset:12288
    ds_read_b64_tr_b16 a[190:191], v239 offset:14336
    s_branch L_woadone
L_woa3:
    ds_read_b64_tr_b16 a[208:209], v239 offset:0
    ds_read_b64_tr_b16 a[210:211], v239 offset:2048
    ds_read_b64_tr_b16 a[212:213], v239 offset:4096
    ds_read_b64_tr_b16 a[214:215], v239 offset:6144
    ds_read_b64_tr_b16 a[216:217], v239 offset:8192
    ds_read_b64_tr_b16 a[218:219], v239 offset:10240
    ds_read_b64_tr_b16 a[220:221], v239 offset:12288
    ds_read_b64_tr_b16 a[222:223], v239 offset:14336
L_woadone:
    v_max3_f32 v230, v148, v149, v230
    v_max3_f32 v230, v150, v151, v230
    v_max3_f32 v230, v152, v153, v230
    v_max3_f32 v230, v154, v155, v230
    v_max3_f32 v230, v156, v157, v230
    v_max3_f32 v230, v158, v159, v230
    v_max3_f32 v230, v160, v161, v230
    v_max3_f32 v230, v162, v163, v230
    v_mov_b32 v231, v230
    v_add_u32 v239, s53, v238
    s_nop 0
    v_permlane32_swap_b32 v231, v230
    v_max_f32 v230, v230, v231
    v_mul_f32 v232, s50, v230
    v_fma_f32 v233, v226, s50, -v232
    v_exp_f32 v234, v233
    v_mov_b32 v226, v230
    v_pk_fma_f32 v[124:125], v[124:125], s[50:51], v[232:233] op_sel_hi:[1,1,0] neg_lo:[0,0,1] neg_hi:[0,0,1]
    v_pk_mul_f32 v[228:229], v[228:229], v[234:235] op_sel_hi:[1,0]
    v_pk_fma_f32 v[126:127], v[126:127], s[50:51], v[232:233] op_sel_hi:[1,1,0] neg_lo:[0,0,1] neg_hi:[0,0,1]
    v_exp_f32 v124, v124
    v_exp_f32 v125, v125
    v_pk_fma_f32 v[128:129], v[128:129], s[50:51], v[232:233] op_sel_hi:[1,1,0] neg_lo:[0,0,1] neg_hi:[0,0,1]
    v_exp_f32 v126, v126
    v_exp_f32 v127, v127
    v_pk_add_f32 v[228:229], v[228:229], v[124:125]
    v_cvt_pk_bf16_f32 v124, v124, v125
    v_pk_fma_f32 v[130:131], v[130:131], s[50:51], v[232:233] op_sel_hi:[1,1,0] neg_lo:[0,0,1] neg_hi:[0,0,1]
    v_exp_f32 v128, v128
    v_exp_f32 v129, v129
    v_pk_add_f32 v[228:229], v[228:229], v[126:127]
    v_cvt_pk_bf16_f32 v125, v126, v127
    v_pk_fma_f32 v[132:133], v[132:133], s[50:51], v[232:233] op_sel_hi:[1,1,0] neg_lo:[0,0,1] neg_hi:[0,0,1]
    v_exp_f32 v130, v130
    v_exp_f32 v131, v131
    v_pk_add_f32 v[228:229], v[228:229], v[128:129]
    v_cvt_pk_bf16_f32 v126, v128, v129
    v_pk_fma_f32 v[134:135], v[134:135], s[50:51], v[232:233] op_sel_hi:[1,1,0] neg_lo:[0,0,1] neg_hi:[0,0,1]
    v_exp_f32 v132, v132
    v_exp_f32 v133, v133
    v_pk_add_f32 v[228:229], v[228:229], v[130:131]
    v_cvt_pk_bf16_f32 v127, v130, v131
    v_pk_fma_f32 v[136:137], v[136:137], s[50:51], v[232:233] op_sel_hi:[1,1,0] neg_lo:[0,0,1] neg_hi:[0,0,1]
    v_exp_f32 v134, v134
    v_exp_f32 v135, v135
    v_pk_add_f32 v[228:229], v[228:229], v[132:133]
    v_cvt_pk_bf16_f32 v128, v132, v133
    v_pk_fma_f32 v[138:139], v[138:139], s[50:51], v[232:233] op_sel_hi:[1,1,0] neg_lo:[0,0,1] neg_hi:[0,0,1]
    v_exp_f32 v136, v136
    v_exp_f32 v137, v137
    v_pk_add_f32 v[228:229], v[228:229], v[134:135]
    v_cvt_pk_bf16_f32 v129, v134, v135
    v_pk_fma_f32 v[140:141], v[140:141], s[50:51], v[232:233] op_sel_hi:[1,1,0] neg_lo:[0,0,1] neg_hi:[0,0,1]
    v_exp_f32 v138, v138
    v_exp_f32 v139, v139
    v_pk_add_f32 v[228:229], v[228:229], v[136:137]
    v_cvt_pk_bf16_f32 v130, v136, v137
    v_pk_fma_f32 v[142:143], v[142:143], s[50:51], v[232:233] op_sel_hi:[1,1,0] neg_lo:[0,0,1] neg_hi:[0,0,1]
    v_exp_f32 v140, v140
    v_exp_f32 v141, v141
    v_pk_add_f32 v[228:229], v[228:229], v[138:139]
    v_cvt_pk_bf16_f32 v131, v138, v139
    v_pk_fma_f32 v[144:145], v[144:145], s[50:51], v[232:233] op_sel_hi:[1,1,0] neg_lo:[0,0,1] neg_hi:[0,0,1]
    v_exp_f32 v142, v142
    v_exp_f32 v143, v143
    v_pk_add_f32 v[228:229], v[228:229], v[140:141]
    v_cvt_pk_bf16_f32 v132, v140, v141
    v_pk_fma_f32 v[146:147], v[146:147], s[50:51], v[232:233] op_sel_hi:[1,1,0] neg_lo:[0,0,1] neg_hi:[0,0,1]
    v_exp_f32 v144, v144
    v_exp_f32 v145, v145
    v_pk_add_f32 v[228:229], v[228:229], v[142:143]
    v_cvt_pk_bf16_f32 v133, v142, v143
    v_pk_fma_f32 v[148:149], v[148:149], s[50:51], v[232:233] op_sel_hi:[1,1,0] neg_lo:[0,0,1] neg_hi:[0,0,1]
    v_exp_f32 v146, v146
    v_exp_f32 v147, v147
    v_pk_add_f32 v[228:229], v[228:229], v[144:145]
    v_cvt_pk_bf16_f32 v134, v144, v145
    v_pk_fma_f32 v[150:151], v[150:151], s[50:51], v[232:233] op_sel_hi:[1,1,0] neg_lo:[0,0,1] neg_hi:[0,0,1]
    v_exp_f32 v148, v148
    v_exp_f32 v149, v149
    v_pk_add_f32 v[228:229], v[228:229], v[146:147]
    v_cvt_pk_bf16_f32 v135, v146, v147
    v_pk_fma_f32 v[152:153], v[152:153], s[50:51], v[232:233] op_sel_hi:[1,1,0] neg_lo:[0,0,1] neg_hi:[0,0,1]
    v_exp_f32 v150, v150
    v_exp_f32 v151, v151
    v_pk_add_f32 v[228:229], v[228:229], v[148:149]
    v_cvt_pk_bf16_f32 v136, v148, v149
    v_pk_fma_f32 v[154:155], v[154:155], s[50:51], v[232:233] op_sel_hi:[1,1,0] neg_lo:[0,0,1] neg_hi:[0,0,1]
    v_exp_f32 v152, v152
    v_exp_f32 v153, v153
    v_pk_add_f32 v[228:229], v[228:229], v[150:151]
    v_cvt_pk_bf16_f32 v137, v150, v151
    v_exp_f32 v154, v154
    v_exp_f32 v155, v155
    v_pk_add_f32 v[228:229], v[228:229], v[152:153]
    v_cvt_pk_bf16_f32 v138, v152, v153
    v_pk_add_f32 v[228:229], v[228:229], v[154:155]
    v_cvt_pk_bf16_f32 v139, v154, v155
    s_cmp_eq_u32 s48, 0
    s_waitcnt lgkmcnt(0)
    s_cbranch_scc1 L_first
    s_barrier
    ds_read_b64_tr_b16 a[64:65], v222 offset:0
    ds_read_b64_tr_b16 a[66:67], v222 offset:2048
    ds_read_b64_tr_b16 a[68:69], v223 offset:0
    ds_read_b64_tr_b16 a[70:71], v223 offset:2048
    ds_read_b64_tr_b16 a[72:73], v224 offset:0
    ds_read_b64_tr_b16 a[74:75], v224 offset:2048
    ds_read_b64_tr_b16 a[76:77], v225 offset:0
    ds_read_b64_tr_b16 a[78:79], v225 offset:2048
    ds_read_b64_tr_b16 a[80:81], v222 offset:4096
    ds_read_b64_tr_b16 a[82:83], v222 offset:6144
    ds_read_b64_tr_b16 a[84:85], v223 offset:4096
    ds_read_b64_tr_b16 a[86:87], v223 offset:6144
    v_pk_fma_f32 v[156:157], v[156:157], s[50:51], v[232:233] op_sel_hi:[1,1,0] neg_lo:[0,0,1] neg_hi:[0,0,1]
    s_nop 0
    v_pk_fma_f32 v[158:159], v[158:159], s[50:51], v[232:233] op_sel_hi:[1,1,0] neg_lo:[0,0,1] neg_hi:[0,0,1]
    v_exp_f32 v156, v156
    v_exp_f32 v157, v157
    v_pk_fma_f32 v[160:161], v[160:161], s[50:51], v[232:233] op_sel_hi:[1,1,0] neg_lo:[0,0,1] neg_hi:[0,0,1]
    v_exp_f32 v158, v158
    v_exp_f32 v159, v159
    v_pk_add_f32 v[228:229], v[228:229], v[156:157]
    v_cvt_pk_bf16_f32 v140, v156, v157
    v_pk_fma_f32 v[162:163], v[162:163], s[50:51], v[232:233] op_sel_hi:[1,1,0] neg_lo:[0,0,1] neg_hi:[0,0,1]
    v_exp_f32 v160, v160
    v_exp_f32 v161, v161
    v_pk_add_f32 v[228:229], v[228:229], v[158:159]
    v_cvt_pk_bf16_f32 v141, v158, v159
    v_exp_f32 v162, v162
    v_exp_f32 v163, v163
    v_pk_add_f32 v[228:229], v[228:229], v[160:161]
    v_cvt_pk_bf16_f32 v142, v160, v161
    v_pk_add_f32 v[228:229], v[228:229], v[162:163]
    v_cvt_pk_bf16_f32 v143, v162, v163
    v_fma_f32 v100, v100, s50, -v232
    s_cmp_lg_u32 s48, 1
    s_cbranch_scc1 L_wob1
    ds_read_b64_tr_b16 a[160:161], v239 offset:0
    ds_read_b64_tr_b16 a[162:163], v239 offset:2048
    ds_read_b64_tr_b16 a[164:165], v239 offset:4096
    ds_read_b64_tr_b16 a[166:167], v239 offset:6144
    ds_read_b64_tr_b16 a[168:169], v239 offset:8192
    ds_read_b64_tr_b16 a[170:171], v239 offset:10240
    ds_read_b64_tr_b16 a[172:173], v239 offset:12288
    ds_read_b64_tr_b16 a[174:175], v239 offset:14336
    s_branch L_wobdone
L_wob1:
    s_cmp_lg_u32 s48, 2
    s_cbranch_scc1 L_wob2
    ds_read_b64_tr_b16 a[192:193], v239 offset:0
    ds_read_b64_tr_b16 a[194:195], v239 offset:2048
    ds_read_b64_tr_b16 a[196:197], v239 offset:4096
    ds_read_b64_tr_b16 a[198:199], v239 offset:6144
    ds_read_b64_tr_b16 a[200:201], v239 offset:8192
    ds_read_b64_tr_b16 a[202:203], v239 offset:10240
    ds_read_b64_tr_b16 a[204:205], v239 offset:12288
    ds_read_b64_tr_b16 a[206:207], v239 offset:14336
    s_branch L_wobdone
L_wob2:
    ds_read_b64_tr_b16 a[224:225], v239 offset:0
    ds_read_b64_tr_b16 a[226:227], v239 offset:2048
    ds_read_b64_tr_b16 a[228:229], v239 offset:4096
    ds_read_b64_tr_b16 a[230:231], v239 offset:6144
    ds_read_b64_tr_b16 a[232:233], v239 offset:8192
    ds_read_b64_tr_b16 a[234:235], v239 offset:10240
    ds_read_b64_tr_b16 a[236:237], v239 offset:12288
    ds_read_b64_tr_b16 a[238:239], v239 offset:14336
L_wobdone:
    s_waitcnt lgkmcnt(8)
    v_mfma_f32_32x32x16_bf16 v[36:51], a[64:67], v[164:167], v[36:51]
    ds_read_b64_tr_b16 a[88:89], v224 offset:4096
    ds_read_b64_tr_b16 a[90:91], v224 offset:6144
    v_exp_f32 v100, v100
    v_fma_f32 v101, v101, s50, -v232
    v_mfma_f32_32x32x16_bf16 v[52:67], a[68:71], v[164:167], v[52:67]
    ds_read_b64_tr_b16 a[92:93], v225 offset:4096
    ds_read_b64_tr_b16 a[94:95], v225 offset:6144
    v_exp_f32 v101, v101
    v_fma_f32 v102, v102, s50, -v232
    v_add_f32 v228, v100, v228
    s_waitcnt lgkmcnt(8)
    v_mfma_f32_32x32x16_bf16 v[68:83], a[72:75], v[164:167], v[68:83]
    ds_read_b64_tr_b16 a[64:65], v222 offset:8192
    ds_read_b64_tr_b16 a[66:67], v222 offset:10240
    v_exp_f32 v102, v102
    v_fma_f32 v103, v103, s50, -v232
    v_add_f32 v229, v101, v229
    v_mfma_f32_32x32x16_bf16 v[84:99], a[76:79], v[164:167], v[84:99]
    ds_read_b64_tr_b16 a[68:69], v223 offset:8192
    ds_read_b64_tr_b16 a[70:71], v223 offset:10240
    s_waitcnt lgkmcnt(8)
    v_mfma_f32_32x32x16_bf16 v[36:51], a[80:83], v[168:171], v[36:51]
    ds_read_b64_tr_b16 a[72:73], v224 offset:8192
    ds_read_b64_tr_b16 a[74:75], v224 offset:10240
    v_exp_f32 v103, v103
    v_fma_f32 v104, v104, s50, -v232
    v_add_f32 v228, v102, v228
    v_cvt_pk_bf16_f32 v164, v100, v101
    v_mfma_f32_32x32x16_bf16 v[52:67], a[84:87], v[168:171], v[52:67]
    ds_read_b64_tr_b16 a[76:77], v225 offset:8192
    ds_read_b64_tr_b16 a[78:79], v225 offset:10240
    v_exp_f32 v104, v104
    v_fma_f32 v105, v105, s50, -v232
    v_add_f32 v229, v103, v229
    s_waitcnt lgkmcnt(8)
    v_mfma_f32_32x32x16_bf16 v[68:83], a[88:91], v[168:171], v[68:83]
    ds_read_b64_tr_b16 a[80:81], v222 offset:12288
    ds_read_b64_tr_b16 a[82:83], v222 offset:14336
    v_exp_f32 v105, v105
    v_fma_f32 v106, v106, s50, -v232
    v_add_f32 v228, v104, v228
    v_cvt_pk_bf16_f32 v165, v102, v103
    v_mfma_f32_32x32x16_bf16 v[84:99], a[92:95], v[168:171], v[84:99]
    ds_read_b64_tr_b16 a[84:85], v223 offset:12288
    ds_read_b64_tr_b16 a[86:87], v223 offset:14336
    s_waitcnt lgkmcnt(8)
    v_mfma_f32_32x32x16_bf16 v[36:51], a[64:67], v[172:175], v[36:51]
    ds_read_b64_tr_b16 a[88:89], v224 offset:12288
    ds_read_b64_tr_b16 a[90:91], v224 offset:14336
    v_exp_f32 v106, v106
    v_fma_f32 v107, v107, s50, -v232
    v_add_f32 v229, v105, v229
    v_mfma_f32_32x32x16_bf16 v[52:67], a[68:71], v[172:175], v[52:67]
    ds_read_b64_tr_b16 a[92:93], v225 offset:12288
    ds_read_b64_tr_b16 a[94:95], v225 offset:14336
    v_exp_f32 v107, v107
    v_fma_f32 v108, v108, s50, -v232
    v_add_f32 v228, v106, v228
    v_cvt_pk_bf16_f32 v166, v104, v105
    s_waitcnt lgkmcnt(8)
    v_mfma_f32_32x32x16_bf16 v[68:83], a[72:75], v[172:175], v[68:83]
    ds_read_b64_tr_b16 a[64:65], v222 offset:16384
    ds_read_b64_tr_b16 a[66:67], v222 offset:18432
    v_exp_f32 v108, v108
    v_fma_f32 v109, v109, s50, -v232
    v_add_f32 v229, v107, v229
    v_mfma_f32_32x32x16_bf16 v[84:99], a[76:79], v[172:175], v[84:99]
    ds_read_b64_tr_b16 a[68:69], v223 offset:16384
    ds_read_b64_tr_b16 a[70:71], v223 offset:18432
    s_waitcnt lgkmcnt(8)
    v_mfma_f32_32x32x16_bf16 v[36:51], a[80:83], v[176:179], v[36:51]
    ds_read_b64_tr_b16 a[72:73], v224 offset:16384
    ds_read_b64_tr_b16 a[74:75], v224 offset:18432
    v_exp_f32 v109, v109
    v_fma_f32 v110, v110, s50, -v232
    v_add_f32 v228, v108, v228
    v_cvt_pk_bf16_f32 v167, v106, v107
    v_mfma_f32_32x32x16_bf16 v[52:67], a[84:87], v[176:179], v[52:67]
    ds_read_b64_tr_b16 a[76:77], v225 offset:16384
    ds_read_b64_tr_b16 a[78:79], v225 offset:18432
    v_exp_f32 v110, v110
    v_fma_f32 v111, v111, s50, -v232
    v_add_f32 v229, v109, v229
    s_waitcnt lgkmcnt(8)
    v_mfma_f32_32x32x16_bf16 v[68:83], a[88:91], v[176:179], v[68:83]
    ds_read_b64_tr_b16 a[80:81], v222 offset:20480
    ds_read_b64_tr_b16 a[82:83], v222 offset:22528
    v_exp_f32 v111, v111
    v_fma_f32 v112, v112, s50, -v232
    v_add_f32 v228, v110, v228
    v_cvt_pk_bf16_f32 v168, v108, v109
    v_mfma_f32_32x32x16_bf16 v[84:99], a[92:95], v[176:179], v[84:99]
    ds_read_b64_tr_b16 a[84:85], v223 offset:20480
    ds_read_b64_tr_b16 a[86:87], v223 offset:22528
    s_waitcnt lgkmcnt(8)
    v_mfma_f32_32x32x16_bf16 v[36:51], a[64:67], v[180:183], v[36:51]
    ds_read_b64_tr_b16 a[88:89], v224 offset:20480
    ds_read_b64_tr_b16 a[90:91], v224 offset:22528
    v_exp_f32 v112, v112
    v_fma_f32 v113, v113, s50, -v232
    v_add_f32 v229, v111, v229
    v_mfma_f32_32x32x16_bf16 v[52:67], a[68:71], v[180:183], v[52:67]
    ds_read_b64_tr_b16 a[92:93], v225 offset:20480
    ds_read_b64_tr_b16 a[94:95], v225 offset:22528
    v_exp_f32 v113, v113
    v_fma_f32 v114, v114, s50, -v232
    v_add_f32 v228, v112, v228
    v_cvt_pk_bf16_f32 v169, v110, v111
    s_waitcnt lgkmcnt(8)
    v_mfma_f32_32x32x16_bf16 v[68:83], a[72:75], v[180:183], v[68:83]
    ds_read_b64_tr_b16 a[64:65], v222 offset:24576
    ds_read_b64_tr_b16 a[66:67], v222 offset:26624
    v_exp_f32 v114, v114
    v_fma_f32 v115, v115, s50, -v232
    v_add_f32 v229, v113, v229
    v_mfma_f32_32x32x16_bf16 v[84:99], a[76:79], v[180:183], v[84:99]
    ds_read_b64_tr_b16 a[68:69], v223 offset:24576
    ds_read_b64_tr_b16 a[70:71], v223 offset:26624
    s_waitcnt lgkmcnt(8)
    v_mfma_f32_32x32x16_bf16 v[36:51], a[80:83], v[184:187], v[36:51]
    ds_read_b64_tr_b16 a[72:73], v224 offset:24576
    ds_read_b64_tr_b16 a[74:75], v224 offset:26624
    v_exp_f32 v115, v115
    v_fma_f32 v116, v116, s50, -v232
    v_add_f32 v228, v114, v228
    v_cvt_pk_bf16_f32 v170, v112, v113
    v_mfma_f32_32x32x16_bf16 v[52:67], a[84:87], v[184:187], v[52:67]
    ds_read_b64_tr_b16 a[76:77], v225 offset:24576
    ds_read_b64_tr_b16 a[78:79], v225 offset:26624
    v_exp_f32 v116, v116
    v_fma_f32 v117, v117, s50, -v232
    v_add_f32 v229, v115, v229
    s_waitcnt lgkmcnt(8)
    v_mfma_f32_32x32x16_bf16 v[68:83], a[88:91], v[184:187], v[68:83]
    ds_read_b64_tr_b16 a[80:81], v222 offset:28672
    ds_read_b64_tr_b16 a[82:83], v222 offset:30720
    v_exp_f32 v117, v117
    v_fma_f32 v118, v118, s50, -v232
    v_add_f32 v228, v116, v228
    v_cvt_pk_bf16_f32 v171, v114, v115
    v_mfma_f32_32x32x16_bf16 v[84:99], a[92:95], v[184:187], v[84:99]
    ds_read_b64_tr_b16 a[84:85], v223 offset:28672
    ds_read_b64_tr_b16 a[86:87], v223 offset:30720
    s_waitcnt lgkmcnt(8)
    v_mfma_f32_32x32x16_bf16 v[36:51], a[64:67], v[188:191], v[36:51]
    ds_read_b64_tr_b16 a[88:89], v224 offset:28672
    ds_read_b64_tr_b16 a[90:91], v224 offset:30720
    v_exp_f32 v118, v118
    v_fma_f32 v119, v119, s50, -v232
    v_add_f32 v229, v117, v229
    v_mfma_f32_32x32x16_bf16 v[52:67], a[68:71], v[188:191], v[52:67]
    ds_read_b64_tr_b16 a[92:93], v225 offset:28672
    ds_read_b64_tr_b16 a[94:95], v225 offset:30720
    v_exp_f32 v119, v119
    v_fma_f32 v120, v120, s50, -v232
    v_add_f32 v228, v118, v228
    v_cvt_pk_bf16_f32 v172, v116, v117
    s_waitcnt lgkmcnt(8)
    v_mfma_f32_32x32x16_bf16 v[68:83], a[72:75], v[188:191], v[68:83]
    v_exp_f32 v120, v120
    v_fma_f32 v121, v121, s50, -v232
    v_add_f32 v229, v119, v229
    v_mfma_f32_32x32x16_bf16 v[84:99], a[76:79], v[188:191], v[84:99]
    s_waitcnt lgkmcnt(4)
    v_mfma_f32_32x32x16_bf16 v[36:51], a[80:83], v[192:195], v[36:51]
    v_exp_f32 v121, v121
    v_fma_f32 v122, v122, s50, -v232
    v_add_f32 v228, v120, v228
    v_cvt_pk_bf16_f32 v173, v118, v119
    v_mfma_f32_32x32x16_bf16 v[52:67], a[84:87], v[192:195], v[52:67]
    v_exp_f32 v122, v122
    v_fma_f32 v123, v123, s50, -v232
    v_add_f32 v229, v121, v229
    s_waitcnt lgkmcnt(0)
    v_mfma_f32_32x32x16_bf16 v[68:83], a[88:91], v[192:195], v[68:83]
    v_exp_f32 v123, v123
    v_add_f32 v228, v122, v228
    v_cvt_pk_bf16_f32 v174, v120, v121
    v_mfma_f32_32x32x16_bf16 v[84:99], a[92:95], v[192:195], v[84:99]
    s_cmp_eq_u32 s48, 3
    s_cbranch_scc1 L_last
    s_add_u32 s48, s48, 1
    s_barrier
    ds_read_b128 a[0:3], v210 offset:0
    ds_read_b128 a[4:7], v211 offset:0
    ds_read_b128 a[8:11], v212 offset:0
    ds_read_b128 a[12:15], v213 offset:0
    ds_read_b128 a[16:19], v214 offset:0
    ds_read_b128 a[20:23], v215 offset:0
    ds_read_b128 a[24:27], v216 offset:0
    ds_read_b128 a[28:31], v217 offset:0
    v_add_f32 v229, v123, v229
    v_cvt_pk_bf16_f32 v175, v122, v123
    v_mov_b64 v[176:177], v[124:125]
    v_mov_b64 v[178:179], v[126:127]
    v_mov_b64 v[180:181], v[128:129]
    v_mov_b64 v[182:183], v[130:131]
    v_mov_b64 v[184:185], v[132:133]
    v_mov_b64 v[186:187], v[134:135]
    v_mov_b64 v[188:189], v[136:137]
    v_mov_b64 v[190:191], v[138:139]
    v_mov_b64 v[192:193], v[140:141]
    v_mov_b64 v[194:195], v[142:143]
    s_mov_b32 s76, s52
    s_mov_b32 s52, s54
    s_mov_b32 s54, s53
    s_mov_b32 s53, s76
    s_branch L_att
L_first:
    v_pk_fma_f32 v[100:101], v[100:101], s[50:51], v[232:233] op_sel_hi:[1,1,0] neg_lo:[0,0,1] neg_hi:[0,0,1]
    s_nop 0
    v_pk_fma_f32 v[102:103], v[102:103], s[50:51], v[232:233] op_sel_hi:[1,1,0] neg_lo:[0,0,1] neg_hi:[0,0,1]
    v_exp_f32 v100, v100
    v_exp_f32 v101, v101
    v_pk_fma_f32 v[104:105], v[104:105], s[50:51], v[232:233] op_sel_hi:[1,1,0] neg_lo:[0,0,1] neg_hi:[0,0,1]
    v_exp_f32 v102, v102
    v_exp_f32 v103, v103
    v_pk_add_f32 v[228:229], v[228:229], v[100:101]
    v_cvt_pk_bf16_f32 v164, v100, v101
    v_pk_fma_f32 v[106:107], v[106:107], s[50:51], v[232:233] op_sel_hi:[1,1,0] neg_lo:[0,0,1] neg_hi:[0,0,1]
    v_exp_f32 v104, v104
    v_exp_f32 v105, v105
    v_pk_add_f32 v[228:229], v[228:229], v[102:103]
    v_cvt_pk_bf16_f32 v165, v102, v103
    v_pk_fma_f32 v[108:109], v[108:109], s[50:51], v[232:233] op_sel_hi:[1,1,0] neg_lo:[0,0,1] neg_hi:[0,0,1]
    v_exp_f32 v106, v106
    v_exp_f32 v107, v107
    v_pk_add_f32 v[228:229], v[228:229], v[104:105]
    v_cvt_pk_bf16_f32 v166, v104, v105
    v_pk_fma_f32 v[110:111], v[110:111], s[50:51], v[232:233] op_sel_hi:[1,1,0] neg_lo:[0,0,1] neg_hi:[0,0,1]
    v_exp_f32 v108, v108
    v_exp_f32 v109, v109
    v_pk_add_f32 v[228:229], v[228:229], v[106:107]
    v_cvt_pk_bf16_f32 v167, v106, v107
    v_pk_fma_f32 v[112:113], v[112:113], s[50:51], v[232:233] op_sel_hi:[1,1,0] neg_lo:[0,0,1] neg_hi:[0,0,1]
    v_exp_f32 v110, v110
    v_exp_f32 v111, v111
    v_pk_add_f32 v[228:229], v[228:229], v[108:109]
    v_cvt_pk_bf16_f32 v168, v108, v109
    v_pk_fma_f32 v[114:115], v[114:115], s[50:51], v[232:233] op_sel_hi:[1,1,0] neg_lo:[0,0,1] neg_hi:[0,0,1]
    v_exp_f32 v112, v112
    v_exp_f32 v113, v113
    v_pk_add_f32 v[228:229], v[228:229], v[110:111]
    v_cvt_pk_bf16_f32 v169, v110, v111
    v_pk_fma_f32 v[116:117], v[116:117], s[50:51], v[232:233] op_sel_hi:[1,1,0] neg_lo:[0,0,1] neg_hi:[0,0,1]
    v_exp_f32 v114, v114
    v_exp_f32 v115, v115
    v_pk_add_f32 v[228:229], v[228:229], v[112:113]
    v_cvt_pk_bf16_f32 v170, v112, v113
    v_pk_fma_f32 v[118:119], v[118:119], s[50:51], v[232:233] op_sel_hi:[1,1,0] neg_lo:[0,0,1] neg_hi:[0,0,1]
    v_exp_f32 v116, v116
    v_exp_f32 v117, v117
    v_pk_add_f32 v[228:229], v[228:229], v[114:115]
    v_cvt_pk_bf16_f32 v171, v114, v115
    v_pk_fma_f32 v[120:121], v[120:121], s[50:51], v[232:233] op_sel_hi:[1,1,0] neg_lo:[0,0,1] neg_hi:[0,0,1]
    v_exp_f32 v118, v118
    v_exp_f32 v119, v119
    v_pk_add_f32 v[228:229], v[228:229], v[116:117]
    v_cvt_pk_bf16_f32 v172, v116, v117
    v_pk_fma_f32 v[122:123], v[122:123], s[50:51], v[232:233] op_sel_hi:[1,1,0] neg_lo:[0,0,1] neg_hi:[0,0,1]
    v_exp_f32 v120, v120
    v_exp_f32 v121, v121
    v_pk_add_f32 v[228:229], v[228:229], v[118:119]
    v_cvt_pk_bf16_f32 v173, v118, v119
    v_exp_f32 v122, v122
    v_exp_f32 v123, v123
    v_pk_add_f32 v[228:229], v[228:229], v[120:121]
    v_cvt_pk_bf16_f32 v174, v120, v121
    v_pk_add_f32 v[228:229], v[228:229], v[122:123]
    v_cvt_pk_bf16_f32 v175, v122, v123
    s_add_u32 s48, s48, 1
    s_barrier
    ds_read_b128 a[0:3], v210 offset:0
    ds_read_b128 a[4:7], v211 offset:0
    ds_read_b128 a[8:11], v212 offset:0
    ds_read_b128 a[12:15], v213 offset:0
    ds_read_b128 a[16:19], v214 offset:0
    ds_read_b128 a[20:23], v215 offset:0
    ds_read_b128 a[24:27], v216 offset:0
    ds_read_b128 a[28:31], v217 offset:0
    v_pk_fma_f32 v[156:157], v[156:157], s[50:51], v[232:233] op_sel_hi:[1,1,0] neg_lo:[0,0,1] neg_hi:[0,0,1]
    s_nop 0
    v_pk_fma_f32 v[158:159], v[158:159], s[50:51], v[232:233] op_sel_hi:[1,1,0] neg_lo:[0,0,1] neg_hi:[0,0,1]
    v_exp_f32 v156, v156
    v_exp_f32 v157, v157
    v_pk_fma_f32 v[160:161], v[160:161], s[50:51], v[232:233] op_sel_hi:[1,1,0] neg_lo:[0,0,1] neg_hi:[0,0,1]
    v_exp_f32 v158, v158
    v_exp_f32 v159, v159
    v_pk_add_f32 v[228:229], v[228:229], v[156:157]
    v_cvt_pk_bf16_f32 v140, v156, v157
    v_pk_fma_f32 v[162:163], v[162:163], s[50:51], v[232:233] op_sel_hi:[1,1,0] neg_lo:[0,0,1] neg_hi:[0,0,1]
    v_exp_f32 v160, v160
    v_exp_f32 v161, v161
    v_pk_add_f32 v[228:229], v[228:229], v[158:159]
    v_cvt_pk_bf16_f32 v141, v158, v159
    v_exp_f32 v162, v162
    v_exp_f32 v163, v163
    v_pk_add_f32 v[228:229], v[228:229], v[160:161]
    v_cvt_pk_bf16_f32 v142, v160, v161
    v_pk_add_f32 v[228:229], v[228:229], v[162:163]
    v_cvt_pk_bf16_f32 v143, v162, v163
    v_mov_b64 v[176:177], v[124:125]
    v_mov_b64 v[178:179], v[126:127]
    v_mov_b64 v[180:181], v[128:129]
    v_mov_b64 v[182:183], v[130:131]
    v_mov_b64 v[184:185], v[132:133]
    v_mov_b64 v[186:187], v[134:135]
    v_mov_b64 v[188:189], v[136:137]
    v_mov_b64 v[190:191], v[138:139]
    v_mov_b64 v[192:193], v[140:141]
    v_mov_b64 v[194:195], v[142:143]
    s_mov_b32 s76, s52
    s_mov_b32 s52, s54
    s_mov_b32 s54, s76
    s_branch L_att
L_last:
    s_barrier
    ds_read_b32 v244, v241 offset:8
    ds_read_b64_tr_b16 a[64:65], v236 offset:0
    ds_read_b64_tr_b16 a[66:67], v236 offset:1024
    ds_read_b64_tr_b16 a[68:69], v237 offset:0
    ds_read_b64_tr_b16 a[70:71], v237 offset:1024
    ds_read_b64_tr_b16 a[72:73], v236 offset:2048
    ds_read_b64_tr_b16 a[74:75], v236 offset:3072
    ds_read_b64_tr_b16 a[76:77], v237 offset:2048
    ds_read_b64_tr_b16 a[78:79], v237 offset:3072
    ds_read_b64_tr_b16 a[80:81], v236 offset:4096
    ds_read_b64_tr_b16 a[82:83], v236 offset:5120
    ds_read_b64_tr_b16 a[84:85], v237 offset:4096
    ds_read_b64_tr_b16 a[86:87], v237 offset:5120
    v_add_f32 v229, v123, v229
    v_cvt_pk_bf16_f32 v175, v122, v123
    v_mov_b64 v[176:177], v[124:125]
    v_mov_b64 v[178:179], v[126:127]
    v_mov_b64 v[180:181], v[128:129]
    v_mov_b64 v[182:183], v[130:131]
    v_mov_b64 v[184:185], v[132:133]
    v_mov_b64 v[186:187], v[134:135]
    v_mov_b64 v[188:189], v[136:137]
    v_mov_b64 v[190:191], v[138:139]
    v_mov_b64 v[192:193], v[140:141]
    v_mov_b64 v[194:195], v[142:143]
    v_pk_mul_f32 v[36:37], v[36:37], v[234:235] op_sel_hi:[1,0]
    v_pk_mul_f32 v[38:39], v[38:39], v[234:235] op_sel_hi:[1,0]
    v_pk_mul_f32 v[40:41], v[40:41], v[234:235] op_sel_hi:[1,0]
    v_pk_mul_f32 v[42:43], v[42:43], v[234:235] op_sel_hi:[1,0]
    v_pk_mul_f32 v[44:45], v[44:45], v[234:235] op_sel_hi:[1,0]
    v_pk_mul_f32 v[46:47], v[46:47], v[234:235] op_sel_hi:[1,0]
    v_pk_mul_f32 v[48:49], v[48:49], v[234:235] op_sel_hi:[1,0]
    v_pk_mul_f32 v[50:51], v[50:51], v[234:235] op_sel_hi:[1,0]
    v_pk_mul_f32 v[52:53], v[52:53], v[234:235] op_sel_hi:[1,0]
    v_pk_mul_f32 v[54:55], v[54:55], v[234:235] op_sel_hi:[1,0]
    v_pk_mul_f32 v[56:57], v[56:57], v[234:235] op_sel_hi:[1,0]
    v_pk_mul_f32 v[58:59], v[58:59], v[234:235] op_sel_hi:[1,0]
    v_pk_mul_f32 v[60:61], v[60:61], v[234:235] op_sel_hi:[1,0]
    v_pk_mul_f32 v[62:63], v[62:63], v[234:235] op_sel_hi:[1,0]
    v_pk_mul_f32 v[64:65], v[64:65], v[234:235] op_sel_hi:[1,0]
    v_pk_mul_f32 v[66:67], v[66:67], v[234:235] op_sel_hi:[1,0]
    v_add_f32 v228, v228, v229
    v_mov_b32 v230, v228
    s_waitcnt lgkmcnt(8)
    v_mfma_f32_32x32x16_bf16 v[36:51], a[64:67], v[164:167], v[36:51]
    ds_read_b64_tr_b16 a[88:89], v236 offset:6144
    ds_read_b64_tr_b16 a[90:91], v236 offset:7168
    v_mul_f32 v68, v234, v68
    v_mul_f32 v69, v234, v69
    v_mul_f32 v70, v234, v70
    v_mfma_f32_32x32x16_bf16 v[52:67], a[68:71], v[164:167], v[52:67]
    ds_read_b64_tr_b16 a[92:93], v237 offset:6144
    ds_read_b64_tr_b16 a[94:95], v237 offset:7168
    v_mul_f32 v71, v234, v71
    v_permlane32_swap_b32 v230, v228
    v_add_f32 v228, v228, v230
    s_waitcnt lgkmcnt(8)
    v_mfma_f32_32x32x16_bf16 v[36:51], a[72:75], v[168:171], v[36:51]
    ds_read_b64_tr_b16 a[64:65], v236 offset:8192
    ds_read_b64_tr_b16 a[66:67], v236 offset:9216
    v_rcp_f32 v230, v228
    v_readfirstlane_b32 s55, v244
    v_mul_f32 v72, v234, v72
    v_mfma_f32_32x32x16_bf16 v[52:67], a[76:79], v[168:171], v[52:67]
    ds_read_b64_tr_b16 a[68:69], v237 offset:8192
    ds_read_b64_tr_b16 a[70:71], v237 offset:9216
    v_mul_f32 v73, v234, v73
    v_mul_f32 v74, v234, v74
    v_mul_f32 v75, v234, v75
    s_waitcnt lgkmcnt(8)
    v_mfma_f32_32x32x16_bf16 v[36:51], a[80:83], v[172:175], v[36:51]
    ds_read_b64_tr_b16 a[72:73], v236 offset:10240
    ds_read_b64_tr_b16 a[74:75], v236 offset:11264
    v_mul_f32 v76, v234, v76
    v_mul_f32 v77, v234, v77
    v_mul_f32 v78, v234, v78
    v_mfma_f32_32x32x16_bf16 v[52:67], a[84:87], v[172:175], v[52:67]
    ds_read_b64_tr_b16 a[76:77], v237 offset:10240
    ds_read_b64_tr_b16 a[78:79], v237 offset:11264
    v_mul_f32 v79, v234, v79
    v_mul_f32 v80, v234, v80
    v_mul_f32 v81, v234, v81
    s_waitcnt lgkmcnt(8)
    v_mfma_f32_32x32x16_bf16 v[36:51], a[88:91], v[176:179], v[36:51]
    ds_read_b64_tr_b16 a[80:81], v236 offset:12288
    ds_read_b64_tr_b16 a[82:83], v236 offset:13312
    v_mul_f32 v82, v234, v82
    v_mul_f32 v83, v234, v83
    v_mul_f32 v84, v234, v84
    v_mfma_f32_32x32x16_bf16 v[52:67], a[92:95], v[176:179], v[52:67]
    ds_read_b64_tr_b16 a[84:85], v237 offset:12288
    ds_read_b64_tr_b16 a[86:87], v237 offset:13312
    v_mul_f32 v85, v234, v85
    v_mul_f32 v86, v234, v86
    v_mul_f32 v87, v234, v87
    s_waitcnt lgkmcnt(8)
    v_mfma_f32_32x32x16_bf16 v[36:51], a[64:67], v[180:183], v[36:51]
    ds_read_b64_tr_b16 a[88:89], v236 offset:14336
    ds_read_b64_tr_b16 a[90:91], v236 offset:15360
    v_mul_f32 v88, v234, v88
    v_mul_f32 v89, v234, v89
    v_mul_f32 v90, v234, v90
    v_mfma_f32_32x32x16_bf16 v[52:67], a[68:71], v[180:183], v[52:67]
    ds_read_b64_tr_b16 a[92:93], v237 offset:14336
    ds_read_b64_tr_b16 a[94:95], v237 offset:15360
    v_mul_f32 v91, v234, v91
    v_mul_f32 v92, v234, v92
    v_mul_f32 v93, v234, v93
    s_waitcnt lgkmcnt(8)
    v_mfma_f32_32x32x16_bf16 v[36:51], a[72:75], v[184:187], v[36:51]
    v_mul_f32 v94, v234, v94
    v_mul_f32 v95, v234, v95
    v_mul_f32 v96, v234, v96
    v_mfma_f32_32x32x16_bf16 v[52:67], a[76:79], v[184:187], v[52:67]
    v_mul_f32 v97, v234, v97
    v_mul_f32 v98, v234, v98
    v_mul_f32 v99, v234, v99
    s_waitcnt lgkmcnt(4)
    v_mfma_f32_32x32x16_bf16 v[36:51], a[80:83], v[188:191], v[36:51]
    v_mfma_f32_32x32x16_bf16 v[52:67], a[84:87], v[188:191], v[52:67]
    s_lshl_b32 s77, s40, 13
    s_mul_i32 s82, s2, 24576
    s_add_u32 s82, s82, s77
    s_add_u32 s83, s82, 0x1000
    s_add_u32 s77, s77, 0x22000
    v_add_u32 v232, s77, v240
    s_waitcnt lgkmcnt(0)
    v_mfma_f32_32x32x16_bf16 v[36:51], a[88:91], v[192:195], v[36:51]
    s_lshl_b32 s84, s2, 8
    s_lshl_b32 s77, s40, 2
    s_add_u32 s84, s84, s77
    s_lshl_b32 s77, s40, 12
    v_add_u32 v233, s77, v240
    v_mfma_f32_32x32x16_bf16 v[52:67], a[92:95], v[192:195], v[52:67]
    s_barrier
    ds_read_b64_tr_b16 a[64:65], v236 offset:16384
    ds_read_b64_tr_b16 a[66:67], v236 offset:17408
    ds_read_b64_tr_b16 a[68:69], v237 offset:16384
    ds_read_b64_tr_b16 a[70:71], v237 offset:17408
    ds_read_b64_tr_b16 a[72:73], v236 offset:18432
    ds_read_b64_tr_b16 a[74:75], v236 offset:19456
    ds_read_b64_tr_b16 a[76:77], v237 offset:18432
    ds_read_b64_tr_b16 a[78:79], v237 offset:19456
    ds_read_b64_tr_b16 a[80:81], v236 offset:20480
    ds_read_b64_tr_b16 a[82:83], v236 offset:21504
    ds_read_b64_tr_b16 a[84:85], v237 offset:20480
    ds_read_b64_tr_b16 a[86:87], v237 offset:21504
    v_pk_mul_f32 v[36:37], v[36:37], v[230:231] op_sel_hi:[1,0]
    v_pk_mul_f32 v[38:39], v[38:39], v[230:231] op_sel_hi:[1,0]
    v_pk_mul_f32 v[40:41], v[40:41], v[230:231] op_sel_hi:[1,0]
    v_pk_mul_f32 v[42:43], v[42:43], v[230:231] op_sel_hi:[1,0]
    v_cvt_pk_bf16_f32 v100, v36, v37
    v_cvt_pk_bf16_f32 v101, v38, v39
    v_cvt_pk_bf16_f32 v102, v40, v41
    v_cvt_pk_bf16_f32 v103, v42, v43
    buffer_store_dwordx4 v[100:103], v240, s[56:59], s82 offen offset:0 sc1
    v_pk_mul_f32 v[44:45], v[44:45], v[230:231] op_sel_hi:[1,0]
    v_pk_mul_f32 v[46:47], v[46:47], v[230:231] op_sel_hi:[1,0]
    v_pk_mul_f32 v[48:49], v[48:49], v[230:231] op_sel_hi:[1,0]
    v_pk_mul_f32 v[50:51], v[50:51], v[230:231] op_sel_hi:[1,0]
    v_cvt_pk_bf16_f32 v104, v44, v45
    v_cvt_pk_bf16_f32 v105, v46, v47
    v_cvt_pk_bf16_f32 v106, v48, v49
    v_cvt_pk_bf16_f32 v107, v50, v51
    buffer_store_dwordx4 v[104:107], v240, s[56:59], s82 offen offset:1024 sc1
    v_pk_mul_f32 v[52:53], v[52:53], v[230:231] op_sel_hi:[1,0]
    v_pk_mul_f32 v[54:55], v[54:55], v[230:231] op_sel_hi:[1,0]
    v_pk_mul_f32 v[56:57], v[56:57], v[230:231] op_sel_hi:[1,0]
    v_pk_mul_f32 v[58:59], v[58:59], v[230:231] op_sel_hi:[1,0]
    v_cvt_pk_bf16_f32 v108, v52, v53
    v_cvt_pk_bf16_f32 v109, v54, v55
    v_cvt_pk_bf16_f32 v110, v56, v57
    v_cvt_pk_bf16_f32 v111, v58, v59
    buffer_store_dwordx4 v[108:111], v240, s[56:59], s82 offen offset:2048 sc1
    v_pk_mul_f32 v[60:61], v[60:61], v[230:231] op_sel_hi:[1,0]
    v_pk_mul_f32 v[62:63], v[62:63], v[230:231] op_sel_hi:[1,0]
    v_pk_mul_f32 v[64:65], v[64:65], v[230:231] op_sel_hi:[1,0]
    v_pk_mul_f32 v[66:67], v[66:67], v[230:231] op_sel_hi:[1,0]
    v_cvt_pk_bf16_f32 v112, v60, v61
    v_cvt_pk_bf16_f32 v113, v62, v63
    v_cvt_pk_bf16_f32 v114, v64, v65
    v_cvt_pk_bf16_f32 v115, v66, v67
    buffer_store_dwordx4 v[112:115], v240, s[56:59], s82 offen offset:3072 sc1
    s_waitcnt lgkmcnt(8)
    v_mfma_f32_32x32x16_bf16 v[68:83], a[64:67], v[164:167], v[68:83]
    ds_read_b64_tr_b16 a[88:89], v236 offset:22528
    ds_read_b64_tr_b16 a[90:91], v236 offset:23552
    v_mfma_f32_32x32x16_bf16 v[84:99], a[68:71], v[164:167], v[84:99]
    ds_read_b64_tr_b16 a[92:93], v237 offset:22528
    ds_read_b64_tr_b16 a[94:95], v237 offset:23552
    s_waitcnt lgkmcnt(8)
    v_mfma_f32_32x32x16_bf16 v[68:83], a[72:75], v[168:171], v[68:83]
    ds_read_b64_tr_b16 a[64:65], v236 offset:24576
    ds_read_b64_tr_b16 a[66:67], v236 offset:25600
    v_mfma_f32_32x32x16_bf16 v[84:99], a[76:79], v[168:171], v[84:99]
    ds_read_b64_tr_b16 a[68:69], v237 offset:24576
    ds_read_b64_tr_b16 a[70:71], v237 offset:25600
    s_waitcnt lgkmcnt(8)
    v_mfma_f32_32x32x16_bf16 v[68:83], a[80:83], v[172:175], v[68:83]
    ds_read_b64_tr_b16 a[72:73], v236 offset:26624
    ds_read_b64_tr_b16 a[74:75], v236 offset:27648
    v_mfma_f32_32x32x16_bf16 v[84:99], a[84:87], v[172:175], v[84:99]
    ds_read_b64_tr_b16 a[76:77], v237 offset:26624
    ds_read_b64_tr_b16 a[78:79], v237 offset:27648
    s_waitcnt lgkmcnt(8)
    v_mfma_f32_32x32x16_bf16 v[68:83], a[88:91], v[176:179], v[68:83]
    v_mfma_f32_32x32x16_bf16 v[84:99], a[92:95], v[176:179], v[84:99]
    s_waitcnt lgkmcnt(4)
    v_mfma_f32_32x32x16_bf16 v[68:83], a[64:67], v[180:183], v[68:83]
    ds_write_b128 v232, v[100:103] offset:0
    v_mfma_f32_32x32x16_bf16 v[84:99], a[68:71], v[180:183], v[84:99]
    ds_write_b128 v232, v[104:107] offset:1024
    s_waitcnt lgkmcnt(0)
    v_mfma_f32_32x32x16_bf16 v[68:83], a[72:75], v[184:187], v[68:83]
    ds_write_b128 v232, v[108:111] offset:2048
    v_mfma_f32_32x32x16_bf16 v[84:99], a[76:79], v[184:187], v[84:99]
    ds_write_b128 v232, v[112:115] offset:3072
    s_barrier
    ds_read_b64_tr_b16 a[80:81], v236 offset:28672
    ds_read_b64_tr_b16 a[82:83], v236 offset:29696
    ds_read_b64_tr_b16 a[84:85], v236 offset:30720
    ds_read_b64_tr_b16 a[86:87], v236 offset:31744
    ds_read_b64_tr_b16 a[88:89], v237 offset:28672
    ds_read_b64_tr_b16 a[90:91], v237 offset:29696
    ds_read_b64_tr_b16 a[92:93], v237 offset:30720
    ds_read_b64_tr_b16 a[94:95], v237 offset:31744
    s_and_b32 s76, s2, 0xf8
    s_lshl_b32 s77, s40, 1
    s_add_u32 s78, s76, s77
    s_mul_i32 s76, s78, 24576
    s_mul_i32 s77, s41, 3072
    s_add_u32 s94, s76, s77
    s_add_u32 s95, s94, 24576
    s_lshl_b32 s78, s78, 8
    s_lshl_b32 s77, s41, 2
    s_add_u32 s96, s78, s77
    s_waitcnt lgkmcnt(6)
    v_mfma_f32_32x32x16_bf16 v[68:83], a[80:83], v[188:191], v[68:83]
    s_waitcnt lgkmcnt(4)
    v_mfma_f32_32x32x16_bf16 v[68:83], a[84:87], v[192:195], v[68:83]
    s_waitcnt lgkmcnt(2)
    v_mfma_f32_32x32x16_bf16 v[84:99], a[88:91], v[188:191], v[84:99]
    s_waitcnt lgkmcnt(0)
    v_mfma_f32_32x32x16_bf16 v[84:99], a[92:95], v[192:195], v[84:99]
    s_waitcnt vmcnt(0)
    s_cmp_eq_u32 s55, 0
    s_cbranch_scc1 L_fl0
    buffer_store_dword v248, v249, s[64:67], s84 offen offset:0 sc1
    s_branch L_fd0
L_fl0:
    buffer_store_dword v248, v249, s[64:67], s84 offen offset:0
L_fd0:
    s_nop 3
    v_pk_mul_f32 v[68:69], v[68:69], v[230:231] op_sel_hi:[1,0]
    v_pk_mul_f32 v[70:71], v[70:71], v[230:231] op_sel_hi:[1,0]
    v_pk_mul_f32 v[72:73], v[72:73], v[230:231] op_sel_hi:[1,0]
    v_pk_mul_f32 v[74:75], v[74:75], v[230:231] op_sel_hi:[1,0]
    v_cvt_pk_bf16_f32 v116, v68, v69
    v_cvt_pk_bf16_f32 v117, v70, v71
    v_cvt_pk_bf16_f32 v118, v72, v73
    v_cvt_pk_bf16_f32 v119, v74, v75
    buffer_store_dwordx4 v[116:119], v240, s[56:59], s83 offen offset:0 sc1
    v_pk_mul_f32 v[76:77], v[76:77], v[230:231] op_sel_hi:[1,0]
    v_pk_mul_f32 v[78:79], v[78:79], v[230:231] op_sel_hi:[1,0]
    v_pk_mul_f32 v[80:81], v[80:81], v[230:231] op_sel_hi:[1,0]
    v_pk_mul_f32 v[82:83], v[82:83], v[230:231] op_sel_hi:[1,0]
    v_cvt_pk_bf16_f32 v120, v76, v77
    v_cvt_pk_bf16_f32 v121, v78, v79
    v_cvt_pk_bf16_f32 v122, v80, v81
    v_cvt_pk_bf16_f32 v123, v82, v83
    buffer_store_dwordx4 v[120:123], v240, s[56:59], s83 offen offset:1024 sc1
    v_pk_mul_f32 v[84:85], v[84:85], v[230:231] op_sel_hi:[1,0]
    v_pk_mul_f32 v[86:87], v[86:87], v[230:231] op_sel_hi:[1,0]
    v_pk_mul_f32 v[88:89], v[88:89], v[230:231] op_sel_hi:[1,0]
    v_pk_mul_f32 v[90:91], v[90:91], v[230:231] op_sel_hi:[1,0]
    v_cvt_pk_bf16_f32 v124, v84, v85
    v_cvt_pk_bf16_f32 v125, v86, v87
    v_cvt_pk_bf16_f32 v126, v88, v89
    v_cvt_pk_bf16_f32 v127, v90, v91
    buffer_store_dwordx4 v[124:127], v240, s[56:59], s83 offen offset:2048 sc1
    v_pk_mul_f32 v[92:93], v[92:93], v[230:231] op_sel_hi:[1,0]
    v_pk_mul_f32 v[94:95], v[94:95], v[230:231] op_sel_hi:[1,0]
    v_pk_mul_f32 v[96:97], v[96:97], v[230:231] op_sel_hi:[1,0]
    v_pk_mul_f32 v[98:99], v[98:99], v[230:231] op_sel_hi:[1,0]
    v_cvt_pk_bf16_f32 v128, v92, v93
    v_cvt_pk_bf16_f32 v129, v94, v95
    v_cvt_pk_bf16_f32 v130, v96, v97
    v_cvt_pk_bf16_f32 v131, v98, v99
    buffer_store_dwordx4 v[128:131], v240, s[56:59], s83 offen offset:3072 sc1
    ds_write_b128 v232, v[116:119] offset:4096
    ds_write_b128 v232, v[120:123] offset:5120
    ds_write_b128 v232, v[124:127] offset:6144
    ds_write_b128 v232, v[128:131] offset:7168
    v_mfma_f32_32x32x16_bf16 a[32:47], a[96:99], v[100:103], 0
    v_mfma_f32_32x32x16_bf16 a[32:47], a[100:103], v[104:107], a[32:47]
    v_mfma_f32_32x32x16_bf16 a[32:47], a[104:107], v[108:111], a[32:47]
    v_mfma_f32_32x32x16_bf16 a[32:47], a[108:111], v[112:115], a[32:47]
    s_mov_b64 exec, 1
    s_waitcnt lgkmcnt(0)
    ds_add_u32 v241, v248
    s_mov_b64 exec, -1
    s_nop 1
    v_mfma_f32_32x32x16_bf16 a[32:47], a[112:115], v[116:119], a[32:47]
    v_mfma_f32_32x32x16_bf16 a[32:47], a[116:119], v[120:123], a[32:47]
    v_mfma_f32_32x32x16_bf16 a[32:47], a[120:123], v[124:127], a[32:47]
    v_mfma_f32_32x32x16_bf16 a[32:47], a[124:127], v[128:131], a[32:47]
    s_nop 11
    ds_write_b128 v233, a[32:35] offset:53248
    ds_write_b128 v233, a[36:39] offset:54272
    ds_write_b128 v233, a[40:43] offset:55296
    ds_write_b128 v233, a[44:47] offset:56320
    s_mov_b32 s78, 0
    s_mov_b32 s49, 0
L_own:
    ds_read_b32 v230, v241
    s_add_u32 s78, s78, 1
    s_waitcnt lgkmcnt(0)
    v_readfirstlane_b32 s76, v230
    s_cmp_ge_u32 s78, 0x400000
    s_cbranch_scc1 L_own_go
    s_cmp_lg_u32 s76, 3
    s_cbranch_scc1 L_own
L_own_go:
    ds_read_b128 a[0:3], v243 offset:24576
    ds_read_b128 a[4:7], v243 offset:25600
    ds_read_b128 a[8:11], v243 offset:26624
    ds_read_b128 a[12:15], v243 offset:27648
    ds_read_b128 a[16:19], v243 offset:28672
    s_waitcnt lgkmcnt(4)
    v_mfma_f32_32x32x16_bf16 v[4:19], a[128:131], a[0:3], 0
    ds_read_b128 a[20:23], v243 offset:29696
    s_waitcnt lgkmcnt(4)
    v_mfma_f32_32x32x16_bf16 v[4:19], a[132:135], a[4:7], v[4:19]
    ds_read_b128 a[0:3], v243 offset:30720
    s_waitcnt lgkmcnt(4)
    v_mfma_f32_32x32x16_bf16 v[4:19], a[136:139], a[8:11], v[4:19]
    ds_read_b128 a[4:7], v243 offset:31744
    s_waitcnt lgkmcnt(4)
    v_mfma_f32_32x32x16_bf16 v[4:19], a[140:143], a[12:15], v[4:19]
    ds_read_b128 a[8:11], v243 offset:32768
    s_waitcnt lgkmcnt(4)
    v_mfma_f32_32x32x16_bf16 v[4:19], a[144:147], a[16:19], v[4:19]
    ds_read_b128 a[12:15], v243 offset:33792
    s_waitcnt vmcnt(0)
    s_cmp_eq_u32 s55, 0
    s_cbranch_scc1 L_fl1
    buffer_store_dword v248, v249, s[64:67], s84 offen offset:16 sc1
    s_branch L_fd1
L_fl1:
    buffer_store_dword v248, v249, s[64:67], s84 offen offset:16
L_fd1:
    s_waitcnt lgkmcnt(4)
    v_mfma_f32_32x32x16_bf16 v[4:19], a[148:151], a[20:23], v[4:19]
    ds_read_b128 a[16:19], v243 offset:34816
    s_waitcnt lgkmcnt(4)
    v_mfma_f32_32x32x16_bf16 v[4:19], a[152:155], a[0:3], v[4:19]
    ds_read_b128 a[20:23], v243 offset:35840
    s_waitcnt lgkmcnt(4)
    v_mfma_f32_32x32x16_bf16 v[4:19], a[156:159], a[4:7], v[4:19]
    ds_read_b128 a[0:3], v243 offset:36864
    s_waitcnt lgkmcnt(4)
    v_mfma_f32_32x32x16_bf16 v[20:35], a[128:131], a[8:11], 0
    ds_read_b128 a[4:7], v243 offset:37888
    s_waitcnt lgkmcnt(4)
    v_mfma_f32_32x32x16_bf16 v[20:35], a[132:135], a[12:15], v[20:35]
    ds_read_b128 a[8:11], v243 offset:38912
    s_waitcnt lgkmcnt(4)
    v_mfma_f32_32x32x16_bf16 v[20:35], a[136:139], a[16:19], v[20:35]
    ds_read_b128 a[12:15], v243 offset:39936
    s_waitcnt lgkmcnt(4)
    v_mfma_f32_32x32x16_bf16 v[20:35], a[140:143], a[20:23], v[20:35]
    ds_read_b128 a[16:19], v243 offset:40960
    s_waitcnt lgkmcnt(4)
    v_mfma_f32_32x32x16_bf16 v[20:35], a[144:147], a[0:3], v[20:35]
    ds_read_b128 a[20:23], v243 offset:41984
    s_waitcnt lgkmcnt(4)
    v_mfma_f32_32x32x16_bf16 v[20:35], a[148:151], a[4:7], v[20:35]
    ds_read_b128 a[0:3], v243 offset:43008
    s_waitcnt lgkmcnt(4)
    v_mfma_f32_32x32x16_bf16 v[20:35], a[152:155], a[8:11], v[20:35]
    ds_read_b128 a[4:7], v243 offset:44032
    s_waitcnt lgkmcnt(4)
    v_mfma_f32_32x32x16_bf16 v[20:35], a[156:159], a[12:15], v[20:35]
    ds_read_b128 a[8:11], v243 offset:45056
    s_waitcnt lgkmcnt(4)
    v_mfma_f32_32x32x16_bf16 v[36:51], a[128:131], a[16:19], 0
    ds_read_b128 a[12:15], v243 offset:46080
    s_waitcnt lgkmcnt(4)
    v_mfma_f32_32x32x16_bf16 v[36:51], a[132:135], a[20:23], v[36:51]
    ds_read_b128 a[16:19], v243 offset:47104
    s_waitcnt lgkmcnt(4)
    v_mfma_f32_32x32x16_bf16 v[36:51], a[136:139], a[0:3], v[36:51]
    ds_read_b128 a[20:23], v243 offset:48128
    s_waitcnt lgkmcnt(4)
    v_mfma_f32_32x32x16_bf16 v[36:51], a[140:143], a[4:7], v[36:51]
    s_waitcnt lgkmcnt(3)
    v_mfma_f32_32x32x16_bf16 v[36:51], a[144:147], a[8:11], v[36:51]
    s_waitcnt lgkmcnt(2)
    v_mfma_f32_32x32x16_bf16 v[36:51], a[148:151], a[12:15], v[36:51]
    s_waitcnt lgkmcnt(1)
    v_mfma_f32_32x32x16_bf16 v[36:51], a[152:155], a[16:19], v[36:51]
    s_waitcnt lgkmcnt(0)
    v_mfma_f32_32x32x16_bf16 v[36:51], a[156:159], a[20:23], v[36:51]
L_bara:
    s_barrier
    ds_read_b128 a[0:3], v242 offset:0
    ds_read_b128 a[4:7], v242 offset:1024
    ds_read_b128 a[8:11], v242 offset:2048
    ds_read_b128 a[12:15], v242 offset:3072
    ds_read_b128 a[16:19], v242 offset:8192
    s_cmp_lg_u32 s40, 3
    s_cbranch_scc1 L_nox
    ds_read_b128 v[4:7], v240 offset:53248
    ds_read_b128 v[8:11], v240 offset:54272
    ds_read_b128 v[12:15], v240 offset:55296
    ds_read_b128 v[16:19], v240 offset:56320
    ds_read_b128 v[20:23], v240 offset:57344
    ds_read_b128 v[24:27], v240 offset:58368
    ds_read_b128 v[28:31], v240 offset:59392
    ds_read_b128 v[32:35], v240 offset:60416
    ds_read_b128 v[36:39], v240 offset:61440
    ds_read_b128 v[40:43], v240 offset:62464
    ds_read_b128 v[44:47], v240 offset:63488
    ds_read_b128 v[48:51], v240 offset:64512
    s_waitcnt lgkmcnt(0)
L_nox:
    s_waitcnt lgkmcnt(4)
    v_mfma_f32_32x32x16_bf16 v[4:19], a[160:163], a[0:3], v[4:19]
    ds_read_b128 a[20:23], v242 offset:9216
    s_waitcnt lgkmcnt(4)
    v_mfma_f32_32x32x16_bf16 v[4:19], a[164:167], a[4:7], v[4:19]
    ds_read_b128 a[0:3], v242 offset:10240
    s_waitcnt lgkmcnt(4)
    v_mfma_f32_32x32x16_bf16 v[4:19], a[168:171], a[8:11], v[4:19]
    ds_read_b128 a[4:7], v242 offset:11264
    s_waitcnt lgkmcnt(4)
    v_mfma_f32_32x32x16_bf16 v[4:19], a[172:175], a[12:15], v[4:19]
    ds_read_b128 a[8:11], v242 offset:16384
    s_waitcnt lgkmcnt(4)
    v_mfma_f32_32x32x16_bf16 v[20:35], a[160:163], a[16:19], v[20:35]
    ds_read_b128 a[12:15], v242 offset:17408
    s_waitcnt lgkmcnt(4)
    v_mfma_f32_32x32x16_bf16 v[20:35], a[164:167], a[20:23], v[20:35]
    ds_read_b128 a[16:19], v242 offset:18432
    s_cmp_eq_u32 s49, 0
    s_cbranch_scc1 L_ck5
    s_call_b64 s[22:23], L_bg
L_ck5:
    s_waitcnt lgkmcnt(4)
    v_mfma_f32_32x32x16_bf16 v[20:35], a[168:171], a[0:3], v[20:35]
    ds_read_b128 a[20:23], v242 offset:19456
    s_waitcnt lgkmcnt(4)
    v_mfma_f32_32x32x16_bf16 v[20:35], a[172:175], a[4:7], v[20:35]
    ds_read_b128 a[0:3], v242 offset:24576
    s_waitcnt lgkmcnt(4)
    v_mfma_f32_32x32x16_bf16 v[36:51], a[160:163], a[8:11], v[36:51]
    ds_read_b128 a[4:7], v242 offset:25600
    ds_read_b64_tr_b16 a[240:241], v238 offset:0
    s_waitcnt lgkmcnt(4)
    v_mfma_f32_32x32x16_bf16 v[36:51], a[164:167], a[12:15], v[36:51]
    ds_read_b128 a[8:11], v242 offset:26624
    ds_read_b64_tr_b16 a[242:243], v238 offset:2048
    s_waitcnt lgkmcnt(4)
    v_mfma_f32_32x32x16_bf16 v[36:51], a[168:171], a[16:19], v[36:51]
    ds_read_b128 a[12:15], v242 offset:27648
    ds_read_b64_tr_b16 a[244:245], v238 offset:4096
    s_waitcnt lgkmcnt(4)
    v_mfma_f32_32x32x16_bf16 v[36:51], a[172:175], a[20:23], v[36:51]
    ds_read_b128 a[16:19], v242 offset:32768
    ds_read_b64_tr_b16 a[246:247], v238 offset:6144
    s_waitcnt lgkmcnt(4)
    v_mfma_f32_32x32x16_bf16 v[4:19], a[192:195], a[0:3], v[4:19]
    ds_read_b128 a[20:23], v242 offset:33792
    ds_read_b64_tr_b16 a[248:249], v238 offset:8192
    s_waitcnt lgkmcnt(4)
    v_mfma_f32_32x32x16_bf16 v[4:19], a[196:199], a[4:7], v[4:19]
    ds_read_b128 a[0:3], v242 offset:34816
    s_cmp_eq_u32 s49, 0
    s_cbranch_scc1 L_ck13
    s_call_b64 s[22:23], L_bg
L_ck13:
    ds_read_b64_tr_b16 a[250:251], v238 offset:10240
    s_waitcnt lgkmcnt(4)
    v_mfma_f32_32x32x16_bf16 v[4:19], a[200:203], a[8:11], v[4:19]
    ds_read_b128 a[4:7], v242 offset:35840
    ds_read_b64_tr_b16 a[252:253], v238 offset:12288
    s_waitcnt lgkmcnt(4)
    v_mfma_f32_32x32x16_bf16 v[4:19], a[204:207], a[12:15], v[4:19]
    ds_read_b128 a[8:11], v242 offset:40960
    ds_read_b64_tr_b16 a[254:255], v238 offset:14336
    s_waitcnt lgkmcnt(4)
    v_mfma_f32_32x32x16_bf16 v[20:35], a[192:195], a[16:19], v[20:35]
    ds_read_b128 a[12:15], v242 offset:41984
    s_waitcnt lgkmcnt(4)
    v_mfma_f32_32x32x16_bf16 v[20:35], a[196:199], a[20:23], v[20:35]
    ds_read_b128 a[16:19], v242 offset:43008
    s_waitcnt lgkmcnt(4)
    v_mfma_f32_32x32x16_bf16 v[20:35], a[200:203], a[0:3], v[20:35]
    ds_read_b128 a[20:23], v242 offset:44032
    s_waitcnt lgkmcnt(4)
    v_mfma_f32_32x32x16_bf16 v[20:35], a[204:207], a[4:7], v[20:35]
    ds_read_b128 a[0:3], v243 offset:0
    s_waitcnt lgkmcnt(4)
    v_mfma_f32_32x32x16_bf16 v[36:51], a[192:195], a[8:11], v[36:51]
    ds_read_b128 a[4:7], v243 offset:1024
    s_waitcnt lgkmcnt(4)
    v_mfma_f32_32x32x16_bf16 v[36:51], a[196:199], a[12:15], v[36:51]
    ds_read_b128 a[8:11], v243 offset:2048
    s_cmp_eq_u32 s49, 0
    s_cbranch_scc1 L_ck21
    s_call_b64 s[22:23], L_bg
L_ck21:
    s_waitcnt lgkmcnt(4)
    v_mfma_f32_32x32x16_bf16 v[36:51], a[200:203], a[16:19], v[36:51]
    ds_read_b128 a[12:15], v243 offset:3072
    s_waitcnt lgkmcnt(4)
    v_mfma_f32_32x32x16_bf16 v[36:51], a[204:207], a[20:23], v[36:51]
    ds_read_b128 a[16:19], v243 offset:8192
    s_waitcnt lgkmcnt(4)
    v_mfma_f32_32x32x16_bf16 v[4:19], a[224:227], a[0:3], v[4:19]
    ds_read_b128 a[20:23], v243 offset:9216
    s_waitcnt lgkmcnt(4)
    v_mfma_f32_32x32x16_bf16 v[4:19], a[228:231], a[4:7], v[4:19]
    ds_read_b128 a[0:3], v243 offset:10240
    s_waitcnt lgkmcnt(4)
    v_mfma_f32_32x32x16_bf16 v[4:19], a[232:235], a[8:11], v[4:19]
    ds_read_b128 a[4:7], v243 offset:11264
    s_waitcnt lgkmcnt(4)
    v_mfma_f32_32x32x16_bf16 v[4:19], a[236:239], a[12:15], v[4:19]
    ds_read_b128 a[8:11], v243 offset:16384
    s_waitcnt lgkmcnt(4)
    v_mfma_f32_32x32x16_bf16 v[20:35], a[224:227], a[16:19], v[20:35]
    ds_read_b128 a[12:15], v243 offset:17408
    s_waitcnt lgkmcnt(4)
    v_mfma_f32_32x32x16_bf16 v[20:35], a[228:231], a[20:23], v[20:35]
    ds_read_b128 a[16:19], v243 offset:18432
    s_cmp_eq_u32 s49, 0
    s_cbranch_scc1 L_ck29
    s_call_b64 s[22:23], L_bg
L_ck29:
    s_waitcnt lgkmcnt(4)
    v_mfma_f32_32x32x16_bf16 v[20:35], a[232:235], a[0:3], v[20:35]
    ds_read_b128 a[20:23], v243 offset:19456
    s_waitcnt lgkmcnt(4)
    v_mfma_f32_32x32x16_bf16 v[20:35], a[236:239], a[4:7], v[20:35]
    s_waitcnt lgkmcnt(3)
    v_mfma_f32_32x32x16_bf16 v[36:51], a[224:227], a[8:11], v[36:51]
    s_waitcnt lgkmcnt(2)
    v_mfma_f32_32x32x16_bf16 v[36:51], a[228:231], a[12:15], v[36:51]
    s_waitcnt lgkmcnt(1)
    v_mfma_f32_32x32x16_bf16 v[36:51], a[232:235], a[16:19], v[36:51]
    s_waitcnt lgkmcnt(0)
    v_mfma_f32_32x32x16_bf16 v[36:51], a[236:239], a[20:23], v[36:51]
    s_mov_b32 s78, 0
L_spinb:
    s_cmp_eq_u32 s49, 0
    s_cbranch_scc1 L_haveb
    s_call_b64 s[22:23], L_bg
    s_add_u32 s78, s78, 1
    s_cmp_lt_u32 s78, 0x400000
    s_cbranch_scc1 L_spinb
L_haveb:
    v_lshlrev_b32 v231, 8, v1
    s_waitcnt vmcnt(0)
    s_barrier
    ds_read_b128 a[0:3], v242 offset:4096
    ds_read_b128 a[4:7], v242 offset:5120
    ds_read_b128 a[8:11], v242 offset:6144
    ds_read_b128 a[12:15], v242 offset:7168
    ds_read_b128 a[16:19], v242 offset:28672
    s_waitcnt lgkmcnt(4)
    v_mfma_f32_32x32x16_bf16 v[4:19], a[176:179], a[0:3], v[4:19]
    ds_read_b128 a[20:23], v242 offset:29696
    s_waitcnt lgkmcnt(4)
    v_mfma_f32_32x32x16_bf16 v[4:19], a[180:183], a[4:7], v[4:19]
    ds_read_b128 a[0:3], v242 offset:30720
    s_waitcnt lgkmcnt(4)
    v_mfma_f32_32x32x16_bf16 v[4:19], a[184:187], a[8:11], v[4:19]
    ds_read_b128 a[4:7], v242 offset:31744
    s_waitcnt lgkmcnt(4)
    v_mfma_f32_32x32x16_bf16 v[4:19], a[188:191], a[12:15], v[4:19]
    ds_read_b128 a[8:11], v243 offset:4096
    s_waitcnt lgkmcnt(4)
    v_mfma_f32_32x32x16_bf16 v[4:19], a[208:211], a[16:19], v[4:19]
    ds_read_b128 a[12:15], v243 offset:5120
    s_waitcnt lgkmcnt(4)
    v_mfma_f32_32x32x16_bf16 v[4:19], a[212:215], a[20:23], v[4:19]
    ds_read_b128 a[16:19], v243 offset:6144
    s_waitcnt lgkmcnt(4)
    v_mfma_f32_32x32x16_bf16 v[4:19], a[216:219], a[0:3], v[4:19]
    ds_read_b128 a[20:23], v243 offset:7168
    s_waitcnt lgkmcnt(4)
    v_mfma_f32_32x32x16_bf16 v[4:19], a[220:223], a[4:7], v[4:19]
    ds_read_b128 a[0:3], v242 offset:12288
    s_waitcnt lgkmcnt(4)
    v_mfma_f32_32x32x16_bf16 v[4:19], a[240:243], a[8:11], v[4:19]
    ds_read_b128 a[4:7], v242 offset:13312
    s_waitcnt lgkmcnt(4)
    v_mfma_f32_32x32x16_bf16 v[4:19], a[244:247], a[12:15], v[4:19]
    ds_read_b128 a[8:11], v242 offset:14336
    s_waitcnt lgkmcnt(4)
    v_mfma_f32_32x32x16_bf16 v[4:19], a[248:251], a[16:19], v[4:19]
    ds_read_b128 a[12:15], v242 offset:15360
    s_waitcnt lgkmcnt(4)
    v_mfma_f32_32x32x16_bf16 v[4:19], a[252:255], a[20:23], v[4:19]
    ds_read_b128 a[16:19], v242 offset:36864
    s_waitcnt lgkmcnt(4)
    v_mfma_f32_32x32x16_bf16 v[20:35], a[176:179], a[0:3], v[20:35]
    ds_read_b128 a[20:23], v242 offset:37888
    s_waitcnt lgkmcnt(4)
    v_mfma_f32_32x32x16_bf16 v[20:35], a[180:183], a[4:7], v[20:35]
    ds_read_b128 a[0:3], v242 offset:38912
    s_waitcnt lgkmcnt(4)
    v_mfma_f32_32x32x16_bf16 v[20:35], a[184:187], a[8:11], v[20:35]
    ds_read_b128 a[4:7], v242 offset:39936
    s_waitcnt lgkmcnt(4)
    v_mfma_f32_32x32x16_bf16 v[20:35], a[188:191], a[12:15], v[20:35]
    ds_read_b128 a[8:11], v243 offset:12288
    v_cvt_pk_bf16_f32 v212, v4, v5
    v_cvt_pk_bf16_f32 v213, v6, v7
    v_cvt_pk_bf16_f32 v214, v8, v9
    s_waitcnt lgkmcnt(4)
    v_mfma_f32_32x32x16_bf16 v[20:35], a[208:211], a[16:19], v[20:35]
    ds_read_b128 a[12:15], v243 offset:13312
    v_cvt_pk_bf16_f32 v215, v10, v11
    buffer_store_dwordx4 v[212:215], v240, s[60:63], s94 offen offset:0 sc1
    v_cvt_pk_bf16_f32 v216, v12, v13
    s_waitcnt lgkmcnt(4)
    v_mfma_f32_32x32x16_bf16 v[20:35], a[212:215], a[20:23], v[20:35]
    ds_read_b128 a[16:19], v243 offset:14336
    v_cvt_pk_bf16_f32 v217, v14, v15
    v_cvt_pk_bf16_f32 v218, v16, v17
    v_cvt_pk_bf16_f32 v219, v18, v19
    s_waitcnt lgkmcnt(4)
    v_mfma_f32_32x32x16_bf16 v[20:35], a[216:219], a[0:3], v[20:35]
    ds_read_b128 a[20:23], v243 offset:15360
    buffer_store_dwordx4 v[216:219], v240, s[60:63], s94 offen offset:1024 sc1
    s_waitcnt lgkmcnt(4)
    v_mfma_f32_32x32x16_bf16 v[20:35], a[220:223], a[4:7], v[20:35]
    ds_read_b128 a[0:3], v242 offset:20480
    s_waitcnt lgkmcnt(4)
    v_mfma_f32_32x32x16_bf16 v[20:35], a[240:243], a[8:11], v[20:35]
    ds_read_b128 a[4:7], v242 offset:21504
    s_waitcnt lgkmcnt(4)
    v_mfma_f32_32x32x16_bf16 v[20:35], a[244:247], a[12:15], v[20:35]
    ds_read_b128 a[8:11], v242 offset:22528
    s_waitcnt lgkmcnt(4)
    v_mfma_f32_32x32x16_bf16 v[20:35], a[248:251], a[16:19], v[20:35]
    ds_read_b128 a[12:15], v242 offset:23552
    s_waitcnt lgkmcnt(4)
    v_mfma_f32_32x32x16_bf16 v[20:35], a[252:255], a[20:23], v[20:35]
    ds_read_b128 a[16:19], v242 offset:45056
    s_waitcnt lgkmcnt(4)
    v_mfma_f32_32x32x16_bf16 v[36:51], a[176:179], a[0:3], v[36:51]
    ds_read_b128 a[20:23], v242 offset:46080
    s_waitcnt lgkmcnt(4)
    v_mfma_f32_32x32x16_bf16 v[36:51], a[180:183], a[4:7], v[36:51]
    ds_read_b128 a[0:3], v242 offset:47104
    s_waitcnt lgkmcnt(4)
    v_mfma_f32_32x32x16_bf16 v[36:51], a[184:187], a[8:11], v[36:51]
    ds_read_b128 a[4:7], v242 offset:48128
    s_waitcnt lgkmcnt(4)
    v_mfma_f32_32x32x16_bf16 v[36:51], a[188:191], a[12:15], v[36:51]
    ds_read_b128 a[8:11], v243 offset:20480
    v_cvt_pk_bf16_f32 v212, v20, v21
    v_cvt_pk_bf16_f32 v213, v22, v23
    v_cvt_pk_bf16_f32 v214, v24, v25
    s_waitcnt lgkmcnt(4)
    v_mfma_f32_32x32x16_bf16 v[36:51], a[208:211], a[16:19], v[36:51]
    ds_read_b128 a[12:15], v243 offset:21504
    v_cvt_pk_bf16_f32 v215, v26, v27
    buffer_store_dwordx4 v[212:215], v240, s[60:63], s94 offen offset:2048 sc1
    v_cvt_pk_bf16_f32 v216, v28, v29
    s_waitcnt lgkmcnt(4)
    v_mfma_f32_32x32x16_bf16 v[36:51], a[212:215], a[20:23], v[36:51]
    ds_read_b128 a[16:19], v243 offset:22528
    v_cvt_pk_bf16_f32 v217, v30, v31
    v_cvt_pk_bf16_f32 v218, v32, v33
    v_cvt_pk_bf16_f32 v219, v34, v35
    s_waitcnt lgkmcnt(4)
    v_mfma_f32_32x32x16_bf16 v[36:51], a[216:219], a[0:3], v[36:51]
    ds_read_b128 a[20:23], v243 offset:23552
    buffer_store_dwordx4 v[216:219], v240, s[60:63], s95 offen offset:0 sc1
    s_waitcnt lgkmcnt(4)
    v_mfma_f32_32x32x16_bf16 v[36:51], a[220:223], a[4:7], v[36:51]
    s_waitcnt lgkmcnt(3)
    v_mfma_f32_32x32x16_bf16 v[36:51], a[240:243], a[8:11], v[36:51]
    s_waitcnt lgkmcnt(2)
    v_mfma_f32_32x32x16_bf16 v[36:51], a[244:247], a[12:15], v[36:51]
    s_waitcnt lgkmcnt(1)
    v_mfma_f32_32x32x16_bf16 v[36:51], a[248:251], a[16:19], v[36:51]
    s_waitcnt lgkmcnt(0)
    v_mfma_f32_32x32x16_bf16 v[36:51], a[252:255], a[20:23], v[36:51]
    s_nop 11
    v_cvt_pk_bf16_f32 v212, v36, v37
    v_cvt_pk_bf16_f32 v213, v38, v39
    v_cvt_pk_bf16_f32 v214, v40, v41
    v_cvt_pk_bf16_f32 v215, v42, v43
    buffer_store_dwordx4 v[212:215], v240, s[60:63], s95 offen offset:1024 sc1
    v_cvt_pk_bf16_f32 v216, v44, v45
    v_cvt_pk_bf16_f32 v217, v46, v47
    v_cvt_pk_bf16_f32 v218, v48, v49
    v_cvt_pk_bf16_f32 v219, v50, v51
    buffer_store_dwordx4 v[216:219], v240, s[60:63], s95 offen offset:2048 sc1
    s_mov_b64 exec, 1
    s_waitcnt vmcnt(3)
    buffer_store_dword v248, v231, s[64:67], s96 offen offset:128 sc1
    s_mov_b64 exec, 2
    s_waitcnt vmcnt(1)
    buffer_store_dword v248, v231, s[64:67], s96 offen offset:128 sc1
    s_mov_b64 exec, -1
    s_cmp_lg_u32 s40, 3
    s_cbranch_scc1 L_red
    s_endpgm
L_red:
    s_mul_i32 s76, s2, 24576
    s_lshl_b32 s77, s40, 10
    s_add_u32 s76, s76, s77
    s_lshl_b32 s79, s2, 8
    v_and_b32 v230, 7, v1
    v_lshlrev_b32 v230, 2, v230
    s_mov_b32 s82, 0
    s_mov_b32 s83, 0
    s_mov_b32 s85, 0
    buffer_load_dword v231, v230, s[64:67], s79 offen offset:128 sc1
    s_and_b32 s77, s41, 1
    s_mul_i32 s77, s77, 3
    s_add_u32 s77, s77, s40
    s_lshr_b32 s78, s77, 1
    s_lshl_b32 s78, s78, 15
    s_and_b32 s77, s77, 1
    s_lshl_b32 s77, s77, 5
    s_add_u32 s78, s78, s77
    s_lshr_b32 s77, s41, 1
    s_lshl_b32 s77, s77, 6
    s_add_u32 s78, s78, s77
    s_xor_b32 s77, s44, 2
    s_lshl_b32 s77, s77, 8
    s_add_u32 s78, s78, s77
    v_and_b32 v232, 31, v1
    v_lshlrev_b32 v232, 10, v232
    v_lshrrev_b32 v233, 5, v1
    v_lshl_add_u32 v232, v233, 4, v232
L_p2:
    s_waitcnt vmcnt(0)
    v_cmp_eq_u32 vcc, 1, v231
    s_andn2_b32 s80, s82, s83
    s_mov_b32 s83, s82
    s_and_b32 s84, vcc_lo, 0xff
    s_andn2_b32 s84, s84, s82
    s_cbranch_scc0 L_p2_noload
    s_or_b32 s82, s82, s84
    s_bitcmp1_b32 s84, 0
    s_cbranch_scc0 L_p2_l0
    buffer_load_dwordx4 v[4:7], v240, s[60:63], s76 offen offset:0 sc1
L_p2_l0:
    s_bitcmp1_b32 s84, 1
    s_cbranch_scc0 L_p2_l1
    buffer_load_dwordx4 v[8:11], v240, s[60:63], s76 offen offset:3072 sc1
L_p2_l1:
    s_bitcmp1_b32 s84, 2
    s_cbranch_scc0 L_p2_l2
    s_add_u32 s77, s76, 0x1800
    buffer_load_dwordx4 v[12:15], v240, s[60:63], s77 offen sc1
L_p2_l2:
    s_bitcmp1_b32 s84, 3
    s_cbranch_scc0 L_p2_l3
    s_add_u32 s77, s76, 0x2400
    buffer_load_dwordx4 v[16:19], v240, s[60:63], s77 offen sc1
L_p2_l3:
    s_bitcmp1_b32 s84, 4
    s_cbranch_scc0 L_p2_l4
    s_add_u32 s77, s76, 0x3000
    buffer_load_dwordx4 v[20:23], v240, s[60:63], s77 offen sc1
L_p2_l4:
    s_bitcmp1_b32 s84, 5
    s_cbranch_scc0 L_p2_l5
    s_add_u32 s77, s76, 0x3c00
    buffer_load_dwordx4 v[24:27], v240, s[60:63], s77 offen sc1
L_p2_l5:
    s_bitcmp1_b32 s84, 6
    s_cbranch_scc0 L_p2_l6
    s_add_u32 s77, s76, 0x4800
    buffer_load_dwordx4 v[28:31], v240, s[60:63], s77 offen sc1
L_p2_l6:
    s_bitcmp1_b32 s84, 7
    s_cbranch_scc0 L_p2_l7
    s_add_u32 s77, s76, 0x5400
    buffer_load_dwordx4 v[32:35], v240, s[60:63], s77 offen sc1
L_p2_l7:
L_p2_noload:
    s_cmp_eq_u32 s82, 0xff
    s_cbranch_scc1 L_p2_nopoll
    buffer_load_dword v231, v230, s[64:67], s79 offen offset:128 sc1
L_p2_nopoll:
    s_cmp_eq_u32 s80, 0
    s_cbranch_scc1 L_p2_nounp
    s_bitcmp1_b32 s80, 0
    s_cbranch_scc0 L_p2_u0
    v_lshlrev_b32 v40, 16, v4
    v_and_b32 v41, 0xffff0000, v4
    v_lshlrev_b32 v42, 16, v5
    v_and_b32 v43, 0xffff0000, v5
    v_lshlrev_b32 v44, 16, v6
    v_and_b32 v45, 0xffff0000, v6
    v_lshlrev_b32 v46, 16, v7
    v_and_b32 v47, 0xffff0000, v7
L_p2_u0:
    s_bitcmp1_b32 s80, 1
    s_cbranch_scc0 L_p2_u1
    v_lshlrev_b32 v48, 16, v8
    v_and_b32 v49, 0xffff0000, v8
    v_lshlrev_b32 v50, 16, v9
    v_and_b32 v51, 0xffff0000, v9
    v_lshlrev_b32 v52, 16, v10
    v_and_b32 v53, 0xffff0000, v10
    v_lshlrev_b32 v54, 16, v11
    v_and_b32 v55, 0xffff0000, v11
L_p2_u1:
    s_bitcmp1_b32 s80, 2
    s_cbranch_scc0 L_p2_u2
    v_lshlrev_b32 v56, 16, v12
    v_and_b32 v57, 0xffff0000, v12
    v_lshlrev_b32 v58, 16, v13
    v_and_b32 v59, 0xffff0000, v13
    v_lshlrev_b32 v60, 16, v14
    v_and_b32 v61, 0xffff0000, v14
    v_lshlrev_b32 v62, 16, v15
    v_and_b32 v63, 0xffff0000, v15
L_p2_u2:
    s_bitcmp1_b32 s80, 3
    s_cbranch_scc0 L_p2_u3
    v_lshlrev_b32 v64, 16, v16
    v_and_b32 v65, 0xffff0000, v16
    v_lshlrev_b32 v66, 16, v17
    v_and_b32 v67, 0xffff0000, v17
    v_lshlrev_b32 v68, 16, v18
    v_and_b32 v69, 0xffff0000, v18
    v_lshlrev_b32 v70, 16, v19
    v_and_b32 v71, 0xffff0000, v19
L_p2_u3:
    s_bitcmp1_b32 s80, 4
    s_cbranch_scc0 L_p2_u4
    v_lshlrev_b32 v72, 16, v20
    v_and_b32 v73, 0xffff0000, v20
    v_lshlrev_b32 v74, 16, v21
    v_and_b32 v75, 0xffff0000, v21
    v_lshlrev_b32 v76, 16, v22
    v_and_b32 v77, 0xffff0000, v22
    v_lshlrev_b32 v78, 16, v23
    v_and_b32 v79, 0xffff0000, v23
L_p2_u4:
    s_bitcmp1_b32 s80, 5
    s_cbranch_scc0 L_p2_u5
    v_lshlrev_b32 v80, 16, v24
    v_and_b32 v81, 0xffff0000, v24
    v_lshlrev_b32 v82, 16, v25
    v_and_b32 v83, 0xffff0000, v25
    v_lshlrev_b32 v84, 16, v26
    v_and_b32 v85, 0xffff0000, v26
    v_lshlrev_b32 v86, 16, v27
    v_and_b32 v87, 0xffff0000, v27
L_p2_u5:
    s_bitcmp1_b32 s80, 6
    s_cbranch_scc0 L_p2_u6
    v_lshlrev_b32 v88, 16, v28
    v_and_b32 v89, 0xffff0000, v28
    v_lshlrev_b32 v90, 16, v29
    v_and_b32 v91, 0xffff0000, v29
    v_lshlrev_b32 v92, 16, v30
    v_and_b32 v93, 0xffff0000, v30
    v_lshlrev_b32 v94, 16, v31
    v_and_b32 v95, 0xffff0000, v31
L_p2_u6:
    s_bitcmp1_b32 s80, 7
    s_cbranch_scc0 L_p2_u7
    v_lshlrev_b32 v96, 16, v32
    v_and_b32 v97, 0xffff0000, v32
    v_lshlrev_b32 v98, 16, v33
    v_and_b32 v99, 0xffff0000, v33
    v_lshlrev_b32 v100, 16, v34
    v_and_b32 v101, 0xffff0000, v34
    v_lshlrev_b32 v102, 16, v35
    v_and_b32 v103, 0xffff0000, v35
L_p2_u7:
L_p2_nounp:
    s_cmp_eq_u32 s83, 0xff
    s_cbranch_scc1 L_p2_done
    s_add_u32 s85, s85, 1
    s_cmp_lt_u32 s85, 0x400000
    s_cbranch_scc1 L_p2
    s_waitcnt vmcnt(0)
L_p2_done:
    v_pk_add_f32 v[40:41], v[40:41], v[48:49]
    v_pk_add_f32 v[42:43], v[42:43], v[50:51]
    v_pk_add_f32 v[44:45], v[44:45], v[52:53]
    v_pk_add_f32 v[46:47], v[46:47], v[54:55]
    v_pk_add_f32 v[56:57], v[56:57], v[64:65]
    v_pk_add_f32 v[58:59], v[58:59], v[66:67]
    v_pk_add_f32 v[60:61], v[60:61], v[68:69]
    v_pk_add_f32 v[62:63], v[62:63], v[70:71]
    v_pk_add_f32 v[72:73], v[72:73], v[80:81]
    v_pk_add_f32 v[74:75], v[74:75], v[82:83]
    v_pk_add_f32 v[76:77], v[76:77], v[84:85]
    v_pk_add_f32 v[78:79], v[78:79], v[86:87]
    v_pk_add_f32 v[88:89], v[88:89], v[96:97]
    v_pk_add_f32 v[90:91], v[90:91], v[98:99]
    v_pk_add_f32 v[92:93], v[92:93], v[100:101]
    v_pk_add_f32 v[94:95], v[94:95], v[102:103]
    v_pk_add_f32 v[40:41], v[40:41], v[56:57]
    v_pk_add_f32 v[42:43], v[42:43], v[58:59]
    v_pk_add_f32 v[44:45], v[44:45], v[60:61]
    v_pk_add_f32 v[46:47], v[46:47], v[62:63]
    v_pk_add_f32 v[72:73], v[72:73], v[88:89]
    v_pk_add_f32 v[74:75], v[74:75], v[90:91]
    v_pk_add_f32 v[76:77], v[76:77], v[92:93]
    v_pk_add_f32 v[78:79], v[78:79], v[94:95]
    v_pk_add_f32 v[40:41], v[40:41], v[72:73]
    v_pk_add_f32 v[42:43], v[42:43], v[74:75]
    v_pk_add_f32 v[44:45], v[44:45], v[76:77]
    v_pk_add_f32 v[46:47], v[46:47], v[78:79]
    v_cvt_pk_bf16_f32 v4, v40, v41
    v_cvt_pk_bf16_f32 v5, v42, v43
    v_cvt_pk_bf16_f32 v6, v44, v45
    v_cvt_pk_bf16_f32 v7, v46, v47
    buffer_store_dwordx4 v[4:7], v232, s[68:71], s78 offen
L_end:
    s_endpgm
.section .rodata,"a"
.p2align 6
.amdhsa_kernel standalone__mha_block_cached__near_ridge_kernel
  .amdhsa_next_free_vgpr 512
  .amdhsa_next_free_sgpr 102
  .amdhsa_accum_offset 256
  .amdhsa_group_segment_fixed_size 0
  .amdhsa_kernarg_size 64
  .amdhsa_user_sgpr_count 2
  .amdhsa_user_sgpr_kernarg_segment_ptr 1
  .amdhsa_system_sgpr_workgroup_id_x 1
.end_amdhsa_kernel
```
